```python
import torch

def _softmax(x, axis=-1):
    return torch.softmax(x, dim=axis)
def _gelu(x):
    return torch.nn.functional.gelu(x, approximate="tanh")
def _silu(x):
    return torch.nn.functional.silu(x)
def _sigmoid(x):
    return torch.sigmoid(x)
def _layernorm(x, axis=-1, eps=1e-5):
    m = x.mean(dim=axis, keepdim=True)
    v = x.var(dim=axis, keepdim=True, unbiased=False)
    return (x - m) / torch.sqrt(v + eps)
def _scatter_add(tgt, idx, src, axis=0):
    return tgt.clone().index_add_(axis, idx, src)
def _segment_sum(src, seg, n):
    out = torch.zeros((n,) + src.shape[1:], dtype=src.dtype)
    return out.index_add_(0, seg, src)
def _pad(x, pw):
    flat = tuple(v for pair in reversed(pw) for v in pair)
    return torch.nn.functional.pad(x, flat)

kernel_name = 'sequential_preLN__sliding_block__glu_gated_glu__prompt'

def setup_inputs():

    _w = (lambda a: (lambda t: t.to(torch.bfloat16) if t.is_floating_point() else t)(torch.as_tensor(a)))
    def _A_setup():
        B, S, D = 1, 2048, 512
        return {
            "x": _w((lambda *s: torch.randn(*s, dtype=torch.bfloat16) * 0.05)(B, S, D)),
            "wqkv": _w((lambda *s: torch.randn(*s, dtype=torch.bfloat16) * 0.05)(D, 3 * D)),
            "wo": _w((lambda *s: torch.randn(*s, dtype=torch.bfloat16) * 0.05)(D, D)),
        }
    _A_in = _A_setup()

    def _B_setup():
        B, S, D, F = 1, 2048, 512, 1792
        return {
            "x": _w((lambda *s: torch.randn(*s, dtype=torch.bfloat16) * 0.05)(B, S, D)),
            "w_gate": _w((lambda *s: torch.randn(*s, dtype=torch.bfloat16) * 0.05)(D, F)),
            "w_up": _w((lambda *s: torch.randn(*s, dtype=torch.bfloat16) * 0.05)(D, F)),
            "w_down": _w((lambda *s: torch.randn(*s, dtype=torch.bfloat16) * 0.05)(F, D)),
        }
    _B_in = _B_setup()

    return {
        "A_x": _A_in["x"],
        "A_wqkv": _A_in["wqkv"],
        "A_wo": _A_in["wo"],
        "B_x": _B_in["x"],
        "B_w_gate": _B_in["w_gate"],
        "B_w_up": _B_in["w_up"],
        "B_w_down": _B_in["w_down"],
    }

def reference(A_x, A_wqkv, A_wo, B_x, B_w_gate, B_w_up, B_w_down):
    def _A_ref(x, wqkv, wo):
        B, S, D = x.shape
        H = 32; Dh = D // H; W = 256
        qkv = (lambda x, *d: x.permute(*d))((x @ wqkv).reshape(B, S, 3, H, Dh), 2, 0, 3, 1, 4)
        q, k, v = qkv[0], qkv[1], qkv[2]
        scores = torch.einsum("bhqd,bhkd->bhqk", q, k) * (Dh ** -0.5)
        idx = torch.arange(S)
        mask = (idx[:, None] - idx[None, :] >= 0) & (idx[:, None] - idx[None, :] < W)
        scores = torch.where(mask[None, None], scores, -1e9)
        p = _softmax(scores, axis=-1)
        o = torch.einsum("bhqk,bhkd->bhqd", p, v)
        return (lambda x, *d: x.permute(*d))(o, 0, 2, 1, 3).reshape(B, S, D) @ wo

    def _B_ref(x, w_gate, w_up, w_down):
        g = torch.einsum("bsd,df->bsf", x, w_gate)
        u = torch.einsum("bsd,df->bsf", x, w_up)
        h = _sigmoid(g) * u
        return torch.einsum("bsf,fd->bsd", h, w_down)

    x = A_x
    h = x + _A_ref(_layernorm(x, axis=-1), A_wqkv, A_wo)
    h2 = h + _B_ref(_layernorm(h, axis=-1), B_w_gate, B_w_up, B_w_down)
    return h2
```

```asm
; @launch grid=(256,1,1) block=(256,1,1) lds=163840
.amdgcn_target "amdgcn-amd-amdhsa--gfx950"
.text
.globl sequential_preLN__sliding_block__glu_gated_glu__prompt_kernel
.p2align 8
.type sequential_preLN__sliding_block__glu_gated_glu__prompt_kernel,@function
sequential_preLN__sliding_block__glu_gated_glu__prompt_kernel:
  s_cmp_ge_u32 s2, 256
  s_cbranch_scc1 L_exit
  s_load_dwordx2 s[4:5], s[0:1], 0
  s_load_dwordx2 s[8:9], s[0:1], 8
  s_load_dwordx2 s[12:13], s[0:1], 72
  s_load_dwordx2 s[32:33], s[0:1], 64
  s_load_dwordx2 s[16:17], s[0:1], 32
  s_load_dwordx2 s[20:21], s[0:1], 40
  s_load_dwordx2 s[24:25], s[0:1], 48
  s_load_dwordx2 s[28:29], s[0:1], 56
  s_load_dwordx2 s[68:69], s[0:1], 16
  s_getpc_b64 s[78:79]
L_pcbase:
  s_lshr_b32 s49, s2, 3
  s_lshl_b32 s56, s49, 10
  v_and_b32 v9, 7, v0
  v_lshl_add_u32 v9, v9, 7, s56
  v_min_u32 v9, L_codeend-L_pcbase-4, v9
  global_load_dword v254, v9, s[78:79]
  v_lshrrev_b32 v3, 6, v0
  v_and_b32 v1, 63, v0
  v_readfirstlane_b32 s36, v3
  v_lshrrev_b32 v4, 3, v1
  v_and_b32 v5, 7, v1
  v_lshlrev_b32 v6, 4, v5
  v_lshl_add_u32 v28, v4, 10, v6
  v_add_u32 v43, 8192, v28
  s_bfe_u32 s94, s2, 0
  s_lshl_b32 s63, s94, 13
  v_xor_b32 v48, s63, v28
  v_xor_b32 v49, s63, v43
  s_bfe_u32 s47, s2, 0x20001
  s_and_b32 s50, s49, 7
  s_lshl3_add_u32 s37, s47, s50
  s_lshr_b32 s51, s49, 3
  s_xor_b32 s39, s49, s51
  s_and_b32 s62, s2, 0xc1
  s_cmp_eq_u32 s62, 0xc0
  s_cselect_b32 s62, 3, 3
  s_and_b32 s39, s39, s62
  s_lshl2_add_u32 s62, s37, s36
  s_lshl_b32 s62, s62, 14
  s_lshl_b32 s63, s39, 8
  s_add_u32 s52, s62, s63
  s_xor_b32 s53, s52, 0x100
  s_xor_b32 s54, s52, 0x200
  s_xor_b32 s55, s52, 0x300
  s_mov_b32 s6, 0x200000
  s_mov_b32 s7, 0x20000
  s_waitcnt lgkmcnt(0)
  buffer_load_dwordx4 v[64:67], v48, s[4:7], s52 offen offset:0
  buffer_load_dwordx4 v[96:99], v49, s[4:7], s52 offen offset:0
  buffer_load_dwordx4 v[68:71], v48, s[4:7], s52 offen offset:128
  buffer_load_dwordx4 v[100:103], v49, s[4:7], s52 offen offset:128
  buffer_load_dwordx4 v[72:75], v48, s[4:7], s53 offen offset:0
  buffer_load_dwordx4 v[104:107], v49, s[4:7], s53 offen offset:0
  buffer_load_dwordx4 v[76:79], v48, s[4:7], s53 offen offset:128
  buffer_load_dwordx4 v[108:111], v49, s[4:7], s53 offen offset:128
  buffer_load_dwordx4 v[80:83], v48, s[4:7], s54 offen offset:0
  buffer_load_dwordx4 v[112:115], v49, s[4:7], s54 offen offset:0
  buffer_load_dwordx4 v[84:87], v48, s[4:7], s54 offen offset:128
  v_lshlrev_b32 v2, 4, v1
  s_and_b32 s48, s2, 1
  s_lshl2_add_u32 s38, s48, s51
  v_lshlrev_b32 v7, 5, v4
  v_and_b32 v7, 64, v7
  v_xor_b32 v7, v7, v6
  v_mul_u32_u24 v8, 3072, v4
  v_add_u32 v29, v8, v7
  v_xor_b32 v7, 32, v29
  v_add_u32 v30, 23552, v7
  v_add_u32 v31, 47104, v29
  v_add_u32 v32, 70656, v7
  s_mov_b32 s10, 1572864
  s_mov_b32 s11, 0x20000
  s_mov_b32 s14, 25165824
  s_mov_b32 s15, 0x20000
  s_mov_b32 s30, 2097152
  s_mov_b32 s31, 0x20000
  s_mov_b32 s34, 256
  s_mov_b32 s35, 0x20000
  s_bfe_u32 s62, s49, 65538
  s_lshl_b32 s83, s62, 14
  s_lshl_b32 s82, s62, 10
  s_lshl_b32 s57, s38, 7
  s_mul_i32 s58, s36, 98304
  s_add_u32 s58, s58, s57
  s_lshl_b32 s59, s36, 12
  s_lshl_b32 s56, s39, 1
  s_xor_b32 s56, s56, s36
  v_mov_b32 v34, 1
  v_mov_b32 v9, 2130706432
  v_cmp_eq_u32 vcc, 0, v1
  v_mov_b32 v15, 0x3f803f80
  s_nop 0
  v_cndmask_b32 v33, v9, v1, vcc
  v_and_b32 v46, 31, v1
  v_lshrrev_b32 v47, 5, v1
  v_xor_b32 v9, v4, v5
  v_lshlrev_b32 v9, 4, v9
  v_lshl_add_u32 v9, v5, 9, v9
  s_lshr_b32 s62, s36, 1
  s_lshl_b32 s62, s62, 15
  s_and_b32 s63, s36, 1
  s_lshl_b32 s85, s63, 8
  s_add_u32 s62, s62, s85
  v_lshl_add_u32 v9, s94, 7, v9
  v_add_u32 v8, s62, v9
  v_xor_b32 v255, 128, v8
  s_lshl_b32 s85, s63, 15
  v_lshrrev_b32 v10, 4, v1
  v_lshl_add_u32 v11, v10, 9, s85
  v_and_b32 v9, 15, v1
  v_xor_b32 v9, v9, v10
  v_lshl_add_u32 v36, v9, 4, v11
  v_xor_b32 v37, 64, v36
  v_bfe_u32 v12, v1, 2, 2
  v_and_b32 v13, 3, v1
  v_bfe_u32 v14, v1, 4, 1
  s_lshr_b32 s62, s36, 1
  s_lshl_b32 s62, s62, 6
  v_lshl_add_u32 v9, v14, 5, s62
  v_lshl_add_u32 v9, v13, 3, v9
  v_lshlrev_b32 v11, 5, v12
  v_and_b32 v11, 64, v11
  v_xor_b32 v9, v9, v11
  v_lshl_add_u32 v9, v12, 7, v9
  v_lshl_add_u32 v9, v10, 10, v9
  v_add_u32 v44, 65536, v9
  v_add_u32 v45, 131072, v9
  v_xor_b32 v38, 32, v44
  v_xor_b32 v39, 32, v45
  v_and_b32 v9, 3, v0
  v_lshl_add_u32 v9, v3, 2, v9
  s_lshl_b32 s62, s2, 11
  v_lshl_add_u32 v41, v9, 7, s62
  v_and_b32 v9, 15, v1
  v_mul_u32_u24 v42, 3072, v9
  s_lshl2_add_u32 s62, s50, s36
  s_mul_i32 s81, s62, 49152
  s_add_u32 s81, s81, s57
  s_lshr_b32 s62, s2, 5
  s_xor_b32 s62, s62, s48
  s_cmp_eq_u32 s62, 6
  s_cselect_b32 s62, 33, 0
  s_xor_b32 s80, s2, s62
  s_lshr_b32 s67, s80, 3
  s_and_b32 s91, s80, 7
  s_and_b32 s63, s80, 1
  s_lshl2_add_u32 s73, s63, s36
  s_lshl2_add_u32 s88, s67, s36
  s_lshl3_add_u32 s88, s88, s91
  v_mul_u32_u24 v40, 3584, v4
  v_add_u32 v40, v40, v6
  s_and_b32 s75, s2, 7
  s_lshl2_add_u32 s84, s91, s36
  s_mul_i32 s85, s84, 57344
  s_lshl_b32 s86, s67, 7
  s_add_u32 s64, s85, s86
  s_add_u32 s87, s86, s84
  s_lshr_b32 s72, s80, 1
  s_nop 0
  s_lshl_b32 s85, s72, 14
  s_lshl_b32 s66, s73, 7
  s_add_u32 s66, s66, s85
  s_cmp_lt_u32 s80, 224
  s_cselect_b32 s18, 1835008, 0
  s_cselect_b32 s74, 25165824, 0
  s_cselect_b32 s64, s64, 0
  s_cselect_b32 s66, s66, 0
  s_add_u32 s65, s64, 28672
  s_mov_b32 s22, s18
  s_mov_b32 s26, s18
  s_mov_b32 s19, 0x20000
  s_mov_b32 s23, 0x20000
  s_mov_b32 s27, 0x20000
  buffer_load_dwordx4 v[116:119], v49, s[4:7], s54 offen offset:128
  buffer_load_dwordx4 v[88:91], v48, s[4:7], s55 offen offset:0
  buffer_load_dwordx4 v[120:123], v49, s[4:7], s55 offen offset:0
  buffer_load_dwordx4 v[92:95], v48, s[4:7], s55 offen offset:128
  buffer_load_dwordx4 v[124:127], v49, s[4:7], s55 offen offset:128
  v_mov_b32 v24, 0
  v_mov_b32 v25, 0
  v_mov_b32 v26, 0
  v_mov_b32 v27, 0
  s_waitcnt vmcnt(15)
  v_dot2c_f32_bf16 v24, v64, v15
  v_dot2c_f32_bf16 v25, v64, v64
  v_dot2c_f32_bf16 v24, v65, v15
  v_dot2c_f32_bf16 v25, v65, v65
  v_dot2c_f32_bf16 v24, v66, v15
  v_dot2c_f32_bf16 v25, v66, v66
  v_dot2c_f32_bf16 v24, v67, v15
  v_dot2c_f32_bf16 v25, v67, v67
  s_waitcnt vmcnt(14)
  v_dot2c_f32_bf16 v26, v96, v15
  v_dot2c_f32_bf16 v27, v96, v96
  v_dot2c_f32_bf16 v26, v97, v15
  v_dot2c_f32_bf16 v27, v97, v97
  v_dot2c_f32_bf16 v26, v98, v15
  v_dot2c_f32_bf16 v27, v98, v98
  v_dot2c_f32_bf16 v26, v99, v15
  v_dot2c_f32_bf16 v27, v99, v99
  s_waitcnt vmcnt(13)
  v_dot2c_f32_bf16 v24, v68, v15
  v_dot2c_f32_bf16 v25, v68, v68
  v_dot2c_f32_bf16 v24, v69, v15
  v_dot2c_f32_bf16 v25, v69, v69
  v_dot2c_f32_bf16 v24, v70, v15
  v_dot2c_f32_bf16 v25, v70, v70
  v_dot2c_f32_bf16 v24, v71, v15
  v_dot2c_f32_bf16 v25, v71, v71
  s_waitcnt vmcnt(12)
  v_dot2c_f32_bf16 v26, v100, v15
  v_dot2c_f32_bf16 v27, v100, v100
  v_dot2c_f32_bf16 v26, v101, v15
  v_dot2c_f32_bf16 v27, v101, v101
  v_dot2c_f32_bf16 v26, v102, v15
  v_dot2c_f32_bf16 v27, v102, v102
  v_dot2c_f32_bf16 v26, v103, v15
  v_dot2c_f32_bf16 v27, v103, v103
  s_waitcnt vmcnt(11)
  v_dot2c_f32_bf16 v24, v72, v15
  v_dot2c_f32_bf16 v25, v72, v72
  v_dot2c_f32_bf16 v24, v73, v15
  v_dot2c_f32_bf16 v25, v73, v73
  v_dot2c_f32_bf16 v24, v74, v15
  v_dot2c_f32_bf16 v25, v74, v74
  v_dot2c_f32_bf16 v24, v75, v15
  v_dot2c_f32_bf16 v25, v75, v75
  s_waitcnt vmcnt(10)
  s_xor_b32 s60, s39, 0
  s_mul_i32 s60, s60, 393216
  s_add_u32 s60, s60, s58
  s_add_u32 s61, s59, s83
  s_add_u32 m0, s61, 65536
  s_add_u32 s61, s60, 1024
  s_add_u32 s60, s61, s82
  buffer_load_dwordx4 v29, s[8:11], s60 offen offset:0  lds
  v_dot2c_f32_bf16 v26, v104, v15
  v_dot2c_f32_bf16 v27, v104, v104
  v_dot2c_f32_bf16 v26, v105, v15
  v_dot2c_f32_bf16 v27, v105, v105
  v_dot2c_f32_bf16 v26, v106, v15
  v_dot2c_f32_bf16 v27, v106, v106
  v_dot2c_f32_bf16 v26, v107, v15
  v_dot2c_f32_bf16 v27, v107, v107
  s_waitcnt vmcnt(10)
  buffer_load_dwordx4 v30, s[8:11], s60 offen offset:1024  lds
  v_dot2c_f32_bf16 v24, v76, v15
  v_dot2c_f32_bf16 v25, v76, v76
  v_dot2c_f32_bf16 v24, v77, v15
  v_dot2c_f32_bf16 v25, v77, v77
  v_dot2c_f32_bf16 v24, v78, v15
  v_dot2c_f32_bf16 v25, v78, v78
  v_dot2c_f32_bf16 v24, v79, v15
  v_dot2c_f32_bf16 v25, v79, v79
  s_waitcnt vmcnt(10)
  buffer_load_dwordx4 v31, s[8:11], s60 offen offset:2048  lds
  v_dot2c_f32_bf16 v26, v108, v15
  v_dot2c_f32_bf16 v27, v108, v108
  v_dot2c_f32_bf16 v26, v109, v15
  v_dot2c_f32_bf16 v27, v109, v109
  v_dot2c_f32_bf16 v26, v110, v15
  v_dot2c_f32_bf16 v27, v110, v110
  v_dot2c_f32_bf16 v26, v111, v15
  v_dot2c_f32_bf16 v27, v111, v111
  s_waitcnt vmcnt(10)
  buffer_load_dwordx4 v32, s[8:11], s60 offen offset:3072  lds
  v_dot2c_f32_bf16 v24, v80, v15
  v_dot2c_f32_bf16 v25, v80, v80
  v_dot2c_f32_bf16 v24, v81, v15
  v_dot2c_f32_bf16 v25, v81, v81
  v_dot2c_f32_bf16 v24, v82, v15
  v_dot2c_f32_bf16 v25, v82, v82
  v_dot2c_f32_bf16 v24, v83, v15
  v_dot2c_f32_bf16 v25, v83, v83
  s_waitcnt vmcnt(10)
  s_xor_b32 m0, m0, 16384
  s_add_u32 s61, s61, 1024
  s_sub_u32 s60, s61, s82
  buffer_load_dwordx4 v29, s[8:11], s60 offen offset:0  lds
  v_dot2c_f32_bf16 v26, v112, v15
  v_dot2c_f32_bf16 v27, v112, v112
  v_dot2c_f32_bf16 v26, v113, v15
  v_dot2c_f32_bf16 v27, v113, v113
  v_dot2c_f32_bf16 v26, v114, v15
  v_dot2c_f32_bf16 v27, v114, v114
  v_dot2c_f32_bf16 v26, v115, v15
  v_dot2c_f32_bf16 v27, v115, v115
  s_waitcnt vmcnt(10)
  buffer_load_dwordx4 v30, s[8:11], s60 offen offset:1024  lds
  v_dot2c_f32_bf16 v24, v84, v15
  v_dot2c_f32_bf16 v25, v84, v84
  v_dot2c_f32_bf16 v24, v85, v15
  v_dot2c_f32_bf16 v25, v85, v85
  v_dot2c_f32_bf16 v24, v86, v15
  v_dot2c_f32_bf16 v25, v86, v86
  v_dot2c_f32_bf16 v24, v87, v15
  v_dot2c_f32_bf16 v25, v87, v87
  s_waitcnt vmcnt(10)
  buffer_load_dwordx4 v31, s[8:11], s60 offen offset:2048  lds
  v_dot2c_f32_bf16 v26, v116, v15
  v_dot2c_f32_bf16 v27, v116, v116
  v_dot2c_f32_bf16 v26, v117, v15
  v_dot2c_f32_bf16 v27, v117, v117
  v_dot2c_f32_bf16 v26, v118, v15
  v_dot2c_f32_bf16 v27, v118, v118
  v_dot2c_f32_bf16 v26, v119, v15
  v_dot2c_f32_bf16 v27, v119, v119
  s_waitcnt vmcnt(10)
  buffer_load_dwordx4 v32, s[8:11], s60 offen offset:3072  lds
  v_dot2c_f32_bf16 v24, v88, v15
  v_dot2c_f32_bf16 v25, v88, v88
  v_dot2c_f32_bf16 v24, v89, v15
  v_dot2c_f32_bf16 v25, v89, v89
  v_dot2c_f32_bf16 v24, v90, v15
  v_dot2c_f32_bf16 v25, v90, v90
  v_dot2c_f32_bf16 v24, v91, v15
  v_dot2c_f32_bf16 v25, v91, v91
  s_waitcnt vmcnt(10)
  buffer_load_dword v254, v42, s[8:11], s81 offen
  v_dot2c_f32_bf16 v26, v120, v15
  v_dot2c_f32_bf16 v27, v120, v120
  v_dot2c_f32_bf16 v26, v121, v15
  v_dot2c_f32_bf16 v27, v121, v121
  v_dot2c_f32_bf16 v26, v122, v15
  v_dot2c_f32_bf16 v27, v122, v122
  v_dot2c_f32_bf16 v26, v123, v15
  v_dot2c_f32_bf16 v27, v123, v123
  s_waitcnt vmcnt(10)
  buffer_load_dwordx4 a[128:131], v40, s[16:19], s64 offen
  v_dot2c_f32_bf16 v24, v92, v15
  v_dot2c_f32_bf16 v25, v92, v92
  v_dot2c_f32_bf16 v24, v93, v15
  v_dot2c_f32_bf16 v25, v93, v93
  v_dot2c_f32_bf16 v24, v94, v15
  v_dot2c_f32_bf16 v25, v94, v94
  v_dot2c_f32_bf16 v24, v95, v15
  v_dot2c_f32_bf16 v25, v95, v95
  s_waitcnt vmcnt(10)
  v_dot2c_f32_bf16 v26, v124, v15
  v_dot2c_f32_bf16 v27, v124, v124
  v_dot2c_f32_bf16 v26, v125, v15
  v_dot2c_f32_bf16 v27, v125, v125
  v_dot2c_f32_bf16 v26, v126, v15
  v_dot2c_f32_bf16 v27, v126, v126
  v_dot2c_f32_bf16 v26, v127, v15
  v_dot2c_f32_bf16 v27, v127, v127
  v_mov_b32 v11, 0x3b000000
  v_add_f32_dpp v24, v24, v24 quad_perm:[1,0,3,2] row_mask:0xf bank_mask:0xf
  v_add_f32_dpp v25, v25, v25 quad_perm:[1,0,3,2] row_mask:0xf bank_mask:0xf
  v_add_f32_dpp v26, v26, v26 quad_perm:[1,0,3,2] row_mask:0xf bank_mask:0xf
  v_add_f32_dpp v27, v27, v27 quad_perm:[1,0,3,2] row_mask:0xf bank_mask:0xf
  v_add_f32_dpp v24, v24, v24 quad_perm:[2,3,0,1] row_mask:0xf bank_mask:0xf
  v_add_f32_dpp v25, v25, v25 quad_perm:[2,3,0,1] row_mask:0xf bank_mask:0xf
  v_add_f32_dpp v26, v26, v26 quad_perm:[2,3,0,1] row_mask:0xf bank_mask:0xf
  v_add_f32_dpp v27, v27, v27 quad_perm:[2,3,0,1] row_mask:0xf bank_mask:0xf
  v_add_f32_dpp v24, v24, v24 row_half_mirror row_mask:0xf bank_mask:0xf
  v_add_f32_dpp v25, v25, v25 row_half_mirror row_mask:0xf bank_mask:0xf
  v_add_f32_dpp v26, v26, v26 row_half_mirror row_mask:0xf bank_mask:0xf
  v_add_f32_dpp v27, v27, v27 row_half_mirror row_mask:0xf bank_mask:0xf
  v_mul_f32 v24, v11, v24
  v_mul_f32 v26, v11, v26
  v_mul_f32 v9, v24, v24
  v_mul_f32 v10, v26, v26
  v_fma_f32 v25, v25, v11, -v9
  v_fma_f32 v27, v27, v11, -v10
  v_max_f32 v25, 0, v25
  v_max_f32 v27, 0, v27
  v_add_f32 v25, 0x3727c5ac, v25
  v_add_f32 v27, 0x3727c5ac, v27
  v_rsq_f32 v25, v25
  v_rsq_f32 v27, v27
  v_mul_f32 v24, -v24, v25
  v_mul_f32 v26, -v26, v27
  s_cmp_ge_u32 s2, 33
  s_cbranch_scc1 L_nozero
  v_mov_b32 v128, 0
  v_mov_b32 v129, 0
  v_mov_b32 v130, 0
  v_mov_b32 v131, 0
  s_lshl2_add_u32 s94, s2, s36
  s_lshl_b32 s94, s94, 10
  buffer_store_dwordx4 v[128:131], v2, s[12:15], s94 offen sc1
L_nozero:
  v_lshlrev_b32 v48, 16, v64
  v_and_b32 v49, 0xffff0000, v64
  v_lshlrev_b32 v50, 16, v65
  v_and_b32 v51, 0xffff0000, v65
  v_lshlrev_b32 v52, 16, v66
  v_and_b32 v53, 0xffff0000, v66
  v_lshlrev_b32 v54, 16, v67
  v_and_b32 v55, 0xffff0000, v67
  v_pk_fma_f32 v[48:49], v[48:49], v[24:25], v[24:25] op_sel:[0,1,0] op_sel_hi:[1,1,0]
  v_pk_fma_f32 v[50:51], v[50:51], v[24:25], v[24:25] op_sel:[0,1,0] op_sel_hi:[1,1,0]
  v_pk_fma_f32 v[52:53], v[52:53], v[24:25], v[24:25] op_sel:[0,1,0] op_sel_hi:[1,1,0]
  v_pk_fma_f32 v[54:55], v[54:55], v[24:25], v[24:25] op_sel:[0,1,0] op_sel_hi:[1,1,0]
  v_cvt_pk_bf16_f32 v64, v48, v49
  v_cvt_pk_bf16_f32 v65, v50, v51
  v_cvt_pk_bf16_f32 v66, v52, v53
  v_cvt_pk_bf16_f32 v67, v54, v55
  v_lshlrev_b32 v48, 16, v96
  v_and_b32 v49, 0xffff0000, v96
  v_lshlrev_b32 v50, 16, v97
  v_and_b32 v51, 0xffff0000, v97
  v_lshlrev_b32 v52, 16, v98
  v_and_b32 v53, 0xffff0000, v98
  v_lshlrev_b32 v54, 16, v99
  v_and_b32 v55, 0xffff0000, v99
  v_pk_fma_f32 v[48:49], v[48:49], v[26:27], v[26:27] op_sel:[0,1,0] op_sel_hi:[1,1,0]
  v_pk_fma_f32 v[50:51], v[50:51], v[26:27], v[26:27] op_sel:[0,1,0] op_sel_hi:[1,1,0]
  v_pk_fma_f32 v[52:53], v[52:53], v[26:27], v[26:27] op_sel:[0,1,0] op_sel_hi:[1,1,0]
  v_pk_fma_f32 v[54:55], v[54:55], v[26:27], v[26:27] op_sel:[0,1,0] op_sel_hi:[1,1,0]
  v_cvt_pk_bf16_f32 v96, v48, v49
  v_cvt_pk_bf16_f32 v97, v50, v51
  v_cvt_pk_bf16_f32 v98, v52, v53
  v_cvt_pk_bf16_f32 v99, v54, v55
  buffer_load_dwordx4 a[132:135], v40, s[16:19], s65 offen
  ds_write_b128 v8, v[64:67] offset:0
  ds_write_b128 v255, v[96:99] offset:0
  v_lshlrev_b32 v48, 16, v68
  v_and_b32 v49, 0xffff0000, v68
  v_lshlrev_b32 v50, 16, v69
  v_and_b32 v51, 0xffff0000, v69
  v_lshlrev_b32 v52, 16, v70
  v_and_b32 v53, 0xffff0000, v70
  v_lshlrev_b32 v54, 16, v71
  v_and_b32 v55, 0xffff0000, v71
  v_pk_fma_f32 v[48:49], v[48:49], v[24:25], v[24:25] op_sel:[0,1,0] op_sel_hi:[1,1,0]
  v_pk_fma_f32 v[50:51], v[50:51], v[24:25], v[24:25] op_sel:[0,1,0] op_sel_hi:[1,1,0]
  v_pk_fma_f32 v[52:53], v[52:53], v[24:25], v[24:25] op_sel:[0,1,0] op_sel_hi:[1,1,0]
  v_pk_fma_f32 v[54:55], v[54:55], v[24:25], v[24:25] op_sel:[0,1,0] op_sel_hi:[1,1,0]
  v_cvt_pk_bf16_f32 v68, v48, v49
  v_cvt_pk_bf16_f32 v69, v50, v51
  v_cvt_pk_bf16_f32 v70, v52, v53
  v_cvt_pk_bf16_f32 v71, v54, v55
  v_lshlrev_b32 v48, 16, v100
  v_and_b32 v49, 0xffff0000, v100
  v_lshlrev_b32 v50, 16, v101
  v_and_b32 v51, 0xffff0000, v101
  v_lshlrev_b32 v52, 16, v102
  v_and_b32 v53, 0xffff0000, v102
  v_lshlrev_b32 v54, 16, v103
  v_and_b32 v55, 0xffff0000, v103
  v_pk_fma_f32 v[48:49], v[48:49], v[26:27], v[26:27] op_sel:[0,1,0] op_sel_hi:[1,1,0]
  v_pk_fma_f32 v[50:51], v[50:51], v[26:27], v[26:27] op_sel:[0,1,0] op_sel_hi:[1,1,0]
  v_pk_fma_f32 v[52:53], v[52:53], v[26:27], v[26:27] op_sel:[0,1,0] op_sel_hi:[1,1,0]
  v_pk_fma_f32 v[54:55], v[54:55], v[26:27], v[26:27] op_sel:[0,1,0] op_sel_hi:[1,1,0]
  v_cvt_pk_bf16_f32 v100, v48, v49
  v_cvt_pk_bf16_f32 v101, v50, v51
  v_cvt_pk_bf16_f32 v102, v52, v53
  v_cvt_pk_bf16_f32 v103, v54, v55
  buffer_load_dwordx4 a[136:139], v40, s[20:23], s64 offen
  ds_write_b128 v8, v[68:71] offset:4096
  ds_write_b128 v255, v[100:103] offset:4096
  v_lshlrev_b32 v48, 16, v72
  v_and_b32 v49, 0xffff0000, v72
  v_lshlrev_b32 v50, 16, v73
  v_and_b32 v51, 0xffff0000, v73
  v_lshlrev_b32 v52, 16, v74
  v_and_b32 v53, 0xffff0000, v74
  v_lshlrev_b32 v54, 16, v75
  v_and_b32 v55, 0xffff0000, v75
  v_pk_fma_f32 v[48:49], v[48:49], v[24:25], v[24:25] op_sel:[0,1,0] op_sel_hi:[1,1,0]
  v_pk_fma_f32 v[50:51], v[50:51], v[24:25], v[24:25] op_sel:[0,1,0] op_sel_hi:[1,1,0]
  v_pk_fma_f32 v[52:53], v[52:53], v[24:25], v[24:25] op_sel:[0,1,0] op_sel_hi:[1,1,0]
  v_pk_fma_f32 v[54:55], v[54:55], v[24:25], v[24:25] op_sel:[0,1,0] op_sel_hi:[1,1,0]
  v_cvt_pk_bf16_f32 v72, v48, v49
  v_cvt_pk_bf16_f32 v73, v50, v51
  v_cvt_pk_bf16_f32 v74, v52, v53
  v_cvt_pk_bf16_f32 v75, v54, v55
  v_lshlrev_b32 v48, 16, v104
  v_and_b32 v49, 0xffff0000, v104
  v_lshlrev_b32 v50, 16, v105
  v_and_b32 v51, 0xffff0000, v105
  v_lshlrev_b32 v52, 16, v106
  v_and_b32 v53, 0xffff0000, v106
  v_lshlrev_b32 v54, 16, v107
  v_and_b32 v55, 0xffff0000, v107
  v_pk_fma_f32 v[48:49], v[48:49], v[26:27], v[26:27] op_sel:[0,1,0] op_sel_hi:[1,1,0]
  v_pk_fma_f32 v[50:51], v[50:51], v[26:27], v[26:27] op_sel:[0,1,0] op_sel_hi:[1,1,0]
  v_pk_fma_f32 v[52:53], v[52:53], v[26:27], v[26:27] op_sel:[0,1,0] op_sel_hi:[1,1,0]
  v_pk_fma_f32 v[54:55], v[54:55], v[26:27], v[26:27] op_sel:[0,1,0] op_sel_hi:[1,1,0]
  v_cvt_pk_bf16_f32 v104, v48, v49
  v_cvt_pk_bf16_f32 v105, v50, v51
  v_cvt_pk_bf16_f32 v106, v52, v53
  v_cvt_pk_bf16_f32 v107, v54, v55
  buffer_load_dwordx4 a[140:143], v40, s[20:23], s65 offen
  ds_write_b128 v8, v[72:75] offset:8192
  ds_write_b128 v255, v[104:107] offset:8192
  v_lshlrev_b32 v48, 16, v76
  v_and_b32 v49, 0xffff0000, v76
  v_lshlrev_b32 v50, 16, v77
  v_and_b32 v51, 0xffff0000, v77
  v_lshlrev_b32 v52, 16, v78
  v_and_b32 v53, 0xffff0000, v78
  v_lshlrev_b32 v54, 16, v79
  v_and_b32 v55, 0xffff0000, v79
  v_pk_fma_f32 v[48:49], v[48:49], v[24:25], v[24:25] op_sel:[0,1,0] op_sel_hi:[1,1,0]
  v_pk_fma_f32 v[50:51], v[50:51], v[24:25], v[24:25] op_sel:[0,1,0] op_sel_hi:[1,1,0]
  v_pk_fma_f32 v[52:53], v[52:53], v[24:25], v[24:25] op_sel:[0,1,0] op_sel_hi:[1,1,0]
  v_pk_fma_f32 v[54:55], v[54:55], v[24:25], v[24:25] op_sel:[0,1,0] op_sel_hi:[1,1,0]
  v_cvt_pk_bf16_f32 v76, v48, v49
  v_cvt_pk_bf16_f32 v77, v50, v51
  v_cvt_pk_bf16_f32 v78, v52, v53
  v_cvt_pk_bf16_f32 v79, v54, v55
  v_lshlrev_b32 v48, 16, v108
  v_and_b32 v49, 0xffff0000, v108
  v_lshlrev_b32 v50, 16, v109
  v_and_b32 v51, 0xffff0000, v109
  v_lshlrev_b32 v52, 16, v110
  v_and_b32 v53, 0xffff0000, v110
  v_lshlrev_b32 v54, 16, v111
  v_and_b32 v55, 0xffff0000, v111
  v_pk_fma_f32 v[48:49], v[48:49], v[26:27], v[26:27] op_sel:[0,1,0] op_sel_hi:[1,1,0]
  v_pk_fma_f32 v[50:51], v[50:51], v[26:27], v[26:27] op_sel:[0,1,0] op_sel_hi:[1,1,0]
  v_pk_fma_f32 v[52:53], v[52:53], v[26:27], v[26:27] op_sel:[0,1,0] op_sel_hi:[1,1,0]
  v_pk_fma_f32 v[54:55], v[54:55], v[26:27], v[26:27] op_sel:[0,1,0] op_sel_hi:[1,1,0]
  v_cvt_pk_bf16_f32 v108, v48, v49
  v_cvt_pk_bf16_f32 v109, v50, v51
  v_cvt_pk_bf16_f32 v110, v52, v53
  v_cvt_pk_bf16_f32 v111, v54, v55
  s_xor_b32 s60, s39, 1
  s_mul_i32 s60, s60, 393216
  s_add_u32 s60, s60, s58
  s_add_u32 m0, s59, 98304
  s_add_u32 s60, s60, 1024
  buffer_load_dwordx4 v29, s[8:11], s60 offen offset:0  lds
  ds_write_b128 v8, v[76:79] offset:12288
  ds_write_b128 v255, v[108:111] offset:12288
  v_lshlrev_b32 v48, 16, v80
  v_and_b32 v49, 0xffff0000, v80
  v_lshlrev_b32 v50, 16, v81
  v_and_b32 v51, 0xffff0000, v81
  v_lshlrev_b32 v52, 16, v82
  v_and_b32 v53, 0xffff0000, v82
  v_lshlrev_b32 v54, 16, v83
  v_and_b32 v55, 0xffff0000, v83
  v_pk_fma_f32 v[48:49], v[48:49], v[24:25], v[24:25] op_sel:[0,1,0] op_sel_hi:[1,1,0]
  v_pk_fma_f32 v[50:51], v[50:51], v[24:25], v[24:25] op_sel:[0,1,0] op_sel_hi:[1,1,0]
  v_pk_fma_f32 v[52:53], v[52:53], v[24:25], v[24:25] op_sel:[0,1,0] op_sel_hi:[1,1,0]
  v_pk_fma_f32 v[54:55], v[54:55], v[24:25], v[24:25] op_sel:[0,1,0] op_sel_hi:[1,1,0]
  v_cvt_pk_bf16_f32 v80, v48, v49
  v_cvt_pk_bf16_f32 v81, v50, v51
  v_cvt_pk_bf16_f32 v82, v52, v53
  v_cvt_pk_bf16_f32 v83, v54, v55
  v_lshlrev_b32 v48, 16, v112
  v_and_b32 v49, 0xffff0000, v112
  v_lshlrev_b32 v50, 16, v113
  v_and_b32 v51, 0xffff0000, v113
  v_lshlrev_b32 v52, 16, v114
  v_and_b32 v53, 0xffff0000, v114
  v_lshlrev_b32 v54, 16, v115
  v_and_b32 v55, 0xffff0000, v115
  v_pk_fma_f32 v[48:49], v[48:49], v[26:27], v[26:27] op_sel:[0,1,0] op_sel_hi:[1,1,0]
  v_pk_fma_f32 v[50:51], v[50:51], v[26:27], v[26:27] op_sel:[0,1,0] op_sel_hi:[1,1,0]
  v_pk_fma_f32 v[52:53], v[52:53], v[26:27], v[26:27] op_sel:[0,1,0] op_sel_hi:[1,1,0]
  v_pk_fma_f32 v[54:55], v[54:55], v[26:27], v[26:27] op_sel:[0,1,0] op_sel_hi:[1,1,0]
  v_cvt_pk_bf16_f32 v112, v48, v49
  v_cvt_pk_bf16_f32 v113, v50, v51
  v_cvt_pk_bf16_f32 v114, v52, v53
  v_cvt_pk_bf16_f32 v115, v54, v55
  buffer_load_dwordx4 v30, s[8:11], s60 offen offset:1024  lds
  ds_write_b128 v8, v[80:83] offset:16384
  ds_write_b128 v255, v[112:115] offset:16384
  v_lshlrev_b32 v48, 16, v84
  v_and_b32 v49, 0xffff0000, v84
  v_lshlrev_b32 v50, 16, v85
  v_and_b32 v51, 0xffff0000, v85
  v_lshlrev_b32 v52, 16, v86
  v_and_b32 v53, 0xffff0000, v86
  v_lshlrev_b32 v54, 16, v87
  v_and_b32 v55, 0xffff0000, v87
  v_pk_fma_f32 v[48:49], v[48:49], v[24:25], v[24:25] op_sel:[0,1,0] op_sel_hi:[1,1,0]
  v_pk_fma_f32 v[50:51], v[50:51], v[24:25], v[24:25] op_sel:[0,1,0] op_sel_hi:[1,1,0]
  v_pk_fma_f32 v[52:53], v[52:53], v[24:25], v[24:25] op_sel:[0,1,0] op_sel_hi:[1,1,0]
  v_pk_fma_f32 v[54:55], v[54:55], v[24:25], v[24:25] op_sel:[0,1,0] op_sel_hi:[1,1,0]
  v_cvt_pk_bf16_f32 v84, v48, v49
  v_cvt_pk_bf16_f32 v85, v50, v51
  v_cvt_pk_bf16_f32 v86, v52, v53
  v_cvt_pk_bf16_f32 v87, v54, v55
  v_lshlrev_b32 v48, 16, v116
  v_and_b32 v49, 0xffff0000, v116
  v_lshlrev_b32 v50, 16, v117
  v_and_b32 v51, 0xffff0000, v117
  v_lshlrev_b32 v52, 16, v118
  v_and_b32 v53, 0xffff0000, v118
  v_lshlrev_b32 v54, 16, v119
  v_and_b32 v55, 0xffff0000, v119
  v_pk_fma_f32 v[48:49], v[48:49], v[26:27], v[26:27] op_sel:[0,1,0] op_sel_hi:[1,1,0]
  v_pk_fma_f32 v[50:51], v[50:51], v[26:27], v[26:27] op_sel:[0,1,0] op_sel_hi:[1,1,0]
  v_pk_fma_f32 v[52:53], v[52:53], v[26:27], v[26:27] op_sel:[0,1,0] op_sel_hi:[1,1,0]
  v_pk_fma_f32 v[54:55], v[54:55], v[26:27], v[26:27] op_sel:[0,1,0] op_sel_hi:[1,1,0]
  v_cvt_pk_bf16_f32 v116, v48, v49
  v_cvt_pk_bf16_f32 v117, v50, v51
  v_cvt_pk_bf16_f32 v118, v52, v53
  v_cvt_pk_bf16_f32 v119, v54, v55
  buffer_load_dwordx4 v31, s[8:11], s60 offen offset:2048  lds
  ds_write_b128 v8, v[84:87] offset:20480
  ds_write_b128 v255, v[116:119] offset:20480
  v_lshlrev_b32 v48, 16, v88
  v_and_b32 v49, 0xffff0000, v88
  v_lshlrev_b32 v50, 16, v89
  v_and_b32 v51, 0xffff0000, v89
  v_lshlrev_b32 v52, 16, v90
  v_and_b32 v53, 0xffff0000, v90
  v_lshlrev_b32 v54, 16, v91
  v_and_b32 v55, 0xffff0000, v91
  v_pk_fma_f32 v[48:49], v[48:49], v[24:25], v[24:25] op_sel:[0,1,0] op_sel_hi:[1,1,0]
  v_pk_fma_f32 v[50:51], v[50:51], v[24:25], v[24:25] op_sel:[0,1,0] op_sel_hi:[1,1,0]
  v_pk_fma_f32 v[52:53], v[52:53], v[24:25], v[24:25] op_sel:[0,1,0] op_sel_hi:[1,1,0]
  v_pk_fma_f32 v[54:55], v[54:55], v[24:25], v[24:25] op_sel:[0,1,0] op_sel_hi:[1,1,0]
  v_cvt_pk_bf16_f32 v88, v48, v49
  v_cvt_pk_bf16_f32 v89, v50, v51
  v_cvt_pk_bf16_f32 v90, v52, v53
  v_cvt_pk_bf16_f32 v91, v54, v55
  v_lshlrev_b32 v48, 16, v120
  v_and_b32 v49, 0xffff0000, v120
  v_lshlrev_b32 v50, 16, v121
  v_and_b32 v51, 0xffff0000, v121
  v_lshlrev_b32 v52, 16, v122
  v_and_b32 v53, 0xffff0000, v122
  v_lshlrev_b32 v54, 16, v123
  v_and_b32 v55, 0xffff0000, v123
  v_pk_fma_f32 v[48:49], v[48:49], v[26:27], v[26:27] op_sel:[0,1,0] op_sel_hi:[1,1,0]
  v_pk_fma_f32 v[50:51], v[50:51], v[26:27], v[26:27] op_sel:[0,1,0] op_sel_hi:[1,1,0]
  v_pk_fma_f32 v[52:53], v[52:53], v[26:27], v[26:27] op_sel:[0,1,0] op_sel_hi:[1,1,0]
  v_pk_fma_f32 v[54:55], v[54:55], v[26:27], v[26:27] op_sel:[0,1,0] op_sel_hi:[1,1,0]
  v_cvt_pk_bf16_f32 v120, v48, v49
  v_cvt_pk_bf16_f32 v121, v50, v51
  v_cvt_pk_bf16_f32 v122, v52, v53
  v_cvt_pk_bf16_f32 v123, v54, v55
  buffer_load_dwordx4 v32, s[8:11], s60 offen offset:3072  lds
  ds_write_b128 v8, v[88:91] offset:24576
  ds_write_b128 v255, v[120:123] offset:24576
  v_lshlrev_b32 v48, 16, v92
  v_and_b32 v49, 0xffff0000, v92
  v_lshlrev_b32 v50, 16, v93
  v_and_b32 v51, 0xffff0000, v93
  v_lshlrev_b32 v52, 16, v94
  v_and_b32 v53, 0xffff0000, v94
  v_lshlrev_b32 v54, 16, v95
  v_and_b32 v55, 0xffff0000, v95
  v_pk_fma_f32 v[48:49], v[48:49], v[24:25], v[24:25] op_sel:[0,1,0] op_sel_hi:[1,1,0]
  v_pk_fma_f32 v[50:51], v[50:51], v[24:25], v[24:25] op_sel:[0,1,0] op_sel_hi:[1,1,0]
  v_pk_fma_f32 v[52:53], v[52:53], v[24:25], v[24:25] op_sel:[0,1,0] op_sel_hi:[1,1,0]
  v_pk_fma_f32 v[54:55], v[54:55], v[24:25], v[24:25] op_sel:[0,1,0] op_sel_hi:[1,1,0]
  v_cvt_pk_bf16_f32 v92, v48, v49
  v_cvt_pk_bf16_f32 v93, v50, v51
  v_cvt_pk_bf16_f32 v94, v52, v53
  v_cvt_pk_bf16_f32 v95, v54, v55
  v_lshlrev_b32 v48, 16, v124
  v_and_b32 v49, 0xffff0000, v124
  v_lshlrev_b32 v50, 16, v125
  v_and_b32 v51, 0xffff0000, v125
  v_lshlrev_b32 v52, 16, v126
  v_and_b32 v53, 0xffff0000, v126
  v_lshlrev_b32 v54, 16, v127
  v_and_b32 v55, 0xffff0000, v127
  v_pk_fma_f32 v[48:49], v[48:49], v[26:27], v[26:27] op_sel:[0,1,0] op_sel_hi:[1,1,0]
  v_pk_fma_f32 v[50:51], v[50:51], v[26:27], v[26:27] op_sel:[0,1,0] op_sel_hi:[1,1,0]
  v_pk_fma_f32 v[52:53], v[52:53], v[26:27], v[26:27] op_sel:[0,1,0] op_sel_hi:[1,1,0]
  v_pk_fma_f32 v[54:55], v[54:55], v[26:27], v[26:27] op_sel:[0,1,0] op_sel_hi:[1,1,0]
  v_cvt_pk_bf16_f32 v124, v48, v49
  v_cvt_pk_bf16_f32 v125, v50, v51
  v_cvt_pk_bf16_f32 v126, v52, v53
  v_cvt_pk_bf16_f32 v127, v54, v55
  s_add_u32 m0, s59, 114688
  s_add_u32 s60, s60, 1024
  buffer_load_dwordx4 v29, s[8:11], s60 offen offset:0  lds
  ds_write_b128 v8, v[92:95] offset:28672
  ds_write_b128 v255, v[124:127] offset:28672
  s_waitcnt vmcnt(10) lgkmcnt(0)
  s_barrier
  ds_read_b128 a[0:3], v36 offset:0
  ds_read_b128 a[4:7], v36 offset:256
  ds_read_b64_tr_b16 v[128:129], v44 offset:0
  ds_read_b64_tr_b16 v[130:131], v44 offset:512
  ds_read_b64_tr_b16 v[132:133], v38 offset:0
  ds_read_b64_tr_b16 v[134:135], v38 offset:512
  ds_read_b64_tr_b16 v[136:137], v44 offset:16384
  ds_read_b64_tr_b16 v[138:139], v44 offset:16896
  ds_read_b64_tr_b16 v[140:141], v38 offset:16384
  ds_read_b64_tr_b16 v[142:143], v38 offset:16896
  ds_read_b128 a[8:11], v37 offset:2048
  ds_read_b128 a[12:15], v37 offset:2304
  ds_read_b64_tr_b16 v[144:145], v44 offset:4096
  ds_read_b64_tr_b16 v[146:147], v44 offset:4608
  ds_read_b64_tr_b16 v[148:149], v38 offset:4096
  ds_read_b64_tr_b16 v[150:151], v38 offset:4608
  s_waitcnt lgkmcnt(12)
  v_mfma_f32_16x16x32_bf16 v[160:163], v[128:131], a[0:3], 0
  s_mul_i32 s91, s36, 8224
  ds_read_b64_tr_b16 v[152:153], v44 offset:20480
  ds_read_b64_tr_b16 v[154:155], v44 offset:20992
  v_mul_u32_u24 v9, 192, v4
  v_mfma_f32_16x16x32_bf16 v[164:167], v[128:131], a[4:7], 0
  ds_read_b64_tr_b16 v[156:157], v38 offset:20480
  v_add3_u32 v63, v9, v6, s91
  v_lshl_add_u32 v11, v47, 3, v12
  s_waitcnt lgkmcnt(13)
  v_mfma_f32_16x16x32_bf16 v[172:175], v[132:135], a[4:7], 0
  ds_read_b64_tr_b16 v[158:159], v38 offset:20992
  buffer_load_dwordx4 v30, s[8:11], s60 offen offset:1024  lds
  v_mul_u32_u24 v11, 192, v11
  v_mfma_f32_16x16x32_bf16 v[168:171], v[132:135], a[0:3], 0
  s_waitcnt lgkmcnt(10)
  ds_read_b128 a[16:19], v36 offset:4096
  v_add_u32 v11, s91, v11
  v_lshl_add_u32 v9, v13, 3, v11
  v_mfma_f32_16x16x32_bf16 v[176:179], a[0:3], v[136:139], 0
  ds_read_b128 a[20:23], v36 offset:4352
  ds_read_b64_tr_b16 v[128:129], v44 offset:8192
  v_mul_u32_u24 v10, 4128, v14
  v_mfma_f32_16x16x32_bf16 v[184:187], a[4:7], v[136:139], 0
  ds_read_b64_tr_b16 v[130:131], v44 offset:8704
  buffer_load_dwordx4 v31, s[8:11], s60 offen offset:2048  lds
  v_add_u32 v60, v9, v10
  v_mfma_f32_16x16x32_bf16 v[188:191], a[4:7], v[140:143], 0
  ds_read_b64_tr_b16 v[132:133], v38 offset:8192
  v_lshl_add_u32 v9, v13, 4, v11
  v_lshl_add_u32 v61, v14, 3, v9
  v_mfma_f32_16x16x32_bf16 v[180:183], a[0:3], v[140:143], 0
  s_waitcnt lgkmcnt(9)
  ds_read_b64_tr_b16 v[134:135], v38 offset:8704
  buffer_load_dwordx4 v32, s[8:11], s60 offen offset:3072  lds
  v_and_b32 v9, 15, v1
  v_mfma_f32_16x16x32_bf16 v[160:163], v[144:147], a[8:11], v[160:163]
  s_xor_b32 s60, s39, 2
  ds_read_b64_tr_b16 v[136:137], v44 offset:24576
  ds_read_b64_tr_b16 v[138:139], v44 offset:25088
  v_lshlrev_b32 v9, 4, v9
  v_mfma_f32_16x16x32_bf16 v[164:167], v[144:147], a[12:15], v[164:167]
  s_mul_i32 s60, s60, 393216
  ds_read_b64_tr_b16 v[140:141], v38 offset:24576
  v_lshl_add_u32 v9, v47, 8, v9
  v_lshl_add_u32 v62, v14, 10, v9
  v_mfma_f32_16x16x32_bf16 v[172:175], v[148:151], a[12:15], v[172:175]
  s_add_u32 s60, s60, s58
  ds_read_b64_tr_b16 v[142:143], v38 offset:25088
  s_add_u32 m0, s59, 131072
  s_add_u32 s60, s60, 1024
  v_mfma_f32_16x16x32_bf16 v[168:171], v[148:151], a[8:11], v[168:171]
  s_waitcnt lgkmcnt(10)
  ds_read_b128 a[24:27], v37 offset:6144
  buffer_load_dwordx4 v29, s[8:11], s60 offen offset:0  lds
  s_and_b32 s85, s87, 1
  v_mfma_f32_16x16x32_bf16 v[176:179], a[8:11], v[152:155], v[176:179]
  s_lshl_b32 s87, s87, 1
  ds_read_b128 a[28:31], v37 offset:6400
  ds_read_b64_tr_b16 v[144:145], v44 offset:12288
  s_sub_u32 s87, s87, s85
  v_mfma_f32_16x16x32_bf16 v[184:187], a[12:15], v[152:155], v[184:187]
  s_lshl_b32 s87, s87, 9
  ds_read_b64_tr_b16 v[146:147], v44 offset:12800
  buffer_load_dwordx4 v30, s[8:11], s60 offen offset:1024  lds
  s_add_u32 s87, s87, 17825792
  v_mfma_f32_16x16x32_bf16 v[188:191], a[12:15], v[156:159], v[188:191]
  s_mul_i32 s85, s72, 147
  ds_read_b64_tr_b16 v[148:149], v38 offset:12288
  s_lshr_b32 s85, s85, 10
  s_lshr_b32 s71, s85, 2
  v_mfma_f32_16x16x32_bf16 v[180:183], a[8:11], v[156:159], v[180:183]
  s_waitcnt lgkmcnt(9)
  ds_read_b64_tr_b16 v[150:151], v38 offset:12800
  buffer_load_dwordx4 v31, s[8:11], s60 offen offset:2048  lds
  s_mul_i32 s86, s85, 7
  v_mfma_f32_16x16x32_bf16 v[160:163], v[128:131], a[16:19], v[160:163]
  s_sub_u32 s86, s72, s86
  ds_read_b64_tr_b16 v[152:153], v44 offset:28672
  ds_read_b64_tr_b16 v[154:155], v44 offset:29184
  s_lshr_b32 s89, s85, 1
  v_mfma_f32_16x16x32_bf16 v[164:167], v[128:131], a[20:23], v[164:167]
  s_mul_i32 s89, s89, 7
  ds_read_b64_tr_b16 v[156:157], v38 offset:28672
  s_add_u32 s89, s89, s86
  s_mul_i32 s90, s73, 56
  v_mfma_f32_16x16x32_bf16 v[172:175], v[132:135], a[20:23], v[172:175]
  s_add_u32 s90, s90, s89
  ds_read_b64_tr_b16 v[158:159], v38 offset:29184
  buffer_load_dwordx4 v32, s[8:11], s60 offen offset:3072  lds
  s_and_b32 s85, s85, 1
  v_mfma_f32_16x16x32_bf16 v[168:171], v[132:135], a[16:19], v[168:171]
  s_waitcnt lgkmcnt(10)
  ds_read_b128 a[32:35], v36 offset:8192
  s_lshl3_add_u32 s90, s90, s85
  s_lshl_b32 s90, s90, 9
  v_mfma_f32_16x16x32_bf16 v[176:179], a[16:19], v[136:139], v[176:179]
  s_add_u32 m0, s59, 147456
  s_waitcnt vmcnt(4) lgkmcnt(0)
  s_barrier
  s_lshl_b32 s94, s36, 8
  s_or_b32 s94, s94, s2
  s_cmp_ge_u32 s94, 33
  s_cbranch_scc1 L_nodbg
  buffer_atomic_add v34, v33, s[32:35], 0 offen sc1
L_nodbg:
  ds_read_b128 a[36:39], v36 offset:8448
  s_add_u32 s90, s90, 22020096
  v_mfma_f32_16x16x32_bf16 v[184:187], a[20:23], v[136:139], v[184:187]
  s_add_u32 s60, s60, 1024
  ds_read_b64_tr_b16 v[128:129], v44 offset:32768
  buffer_load_dwordx4 v29, s[8:11], s60 offen offset:0  lds
  s_lshl_b32 s88, s88, 7
  v_mfma_f32_16x16x32_bf16 v[188:191], a[20:23], v[140:143], v[188:191]
  s_add_u32 s88, s88, 24117248
  ds_read_b64_tr_b16 v[130:131], v44 offset:33280
  ds_read_b64_tr_b16 v[132:133], v38 offset:32768
  s_and_b32 s62, s49, 3
  v_mfma_f32_16x16x32_bf16 v[180:183], a[16:19], v[140:143], v[180:183]
  s_lshl2_add_u32 s42, s47, s62
  ds_read_b64_tr_b16 v[134:135], v38 offset:33280
  buffer_load_dwordx4 v30, s[8:11], s60 offen offset:1024  lds
  s_lshr_b32 s45, s49, 2
  v_mfma_f32_16x16x32_bf16 v[160:163], v[144:147], a[24:27], v[160:163]
  s_lshl3_add_u32 s43, s48, s45
  ds_read_b64_tr_b16 v[136:137], v44 offset:49152
  ds_read_b64_tr_b16 v[138:139], v44 offset:49664
  s_lshl2_add_u32 s44, s75, s62
  v_mfma_f32_16x16x32_bf16 v[164:167], v[144:147], a[28:31], v[164:167]
  s_and_b32 s63, s36, 1
  ds_read_b64_tr_b16 v[140:141], v38 offset:49152
  s_lshl1_add_u32 s46, s37, s63
  s_lshl3_add_u32 s92, s46, s38
  v_mfma_f32_16x16x32_bf16 v[172:175], v[148:151], a[28:31], v[172:175]
  s_lshr_b32 s62, s36, 1
  ds_read_b64_tr_b16 v[142:143], v38 offset:49664
  buffer_load_dwordx4 v31, s[8:11], s60 offen offset:2048  lds
  s_lshl1_add_u32 s92, s92, s62
  v_mfma_f32_16x16x32_bf16 v[168:171], v[148:151], a[24:27], v[168:171]
  s_lshl_b32 s92, s92, 12
  ds_read_b128 a[40:43], v37 offset:10240
  s_add_u32 s92, s92, 1048576
  s_mul_i32 s62, s62, 41120
  v_mfma_f32_16x16x32_bf16 v[176:179], a[24:27], v[152:155], v[176:179]
  s_mul_i32 s63, s63, 4112
  ds_read_b128 a[44:47], v37 offset:10496
  ds_read_b64_tr_b16 v[144:145], v44 offset:36864
  s_add_u32 s93, s62, s63
  v_mfma_f32_16x16x32_bf16 v[184:187], a[28:31], v[152:155], v[184:187]
  s_lshl3_add_u32 s70, s37, s38
  ds_read_b64_tr_b16 v[146:147], v44 offset:37376
  buffer_load_dwordx4 v32, s[8:11], s60 offen offset:3072  lds
  s_lshl_b32 s70, s70, 7
  v_mfma_f32_16x16x32_bf16 v[188:191], a[28:31], v[156:159], v[188:191]
  ds_read_b64_tr_b16 v[148:149], v38 offset:36864
  v_add_u32 v3, s93, v2
  v_lshlrev_b32 v9, 3, v47
  v_mfma_f32_16x16x32_bf16 v[180:183], a[24:27], v[156:159], v[180:183]
  s_waitcnt lgkmcnt(9)
  ds_read_b64_tr_b16 v[150:151], v38 offset:37376
  global_load_dword v254, v41, s[68:69]
  v_sub_u32 v252, v46, v9
  v_mfma_f32_16x16x32_bf16 v[160:163], v[128:131], a[32:35], v[160:163]
  ds_read_b64_tr_b16 v[152:153], v44 offset:53248
  ds_read_b64_tr_b16 v[154:155], v44 offset:53760
  v_lshlrev_b32 v9, 11, v4
  v_mfma_f32_16x16x32_bf16 v[164:167], v[128:131], a[36:39], v[164:167]
  ds_read_b64_tr_b16 v[156:157], v38 offset:53248
  v_sub_u32 v56, v29, v9
  v_add_u32 v57, 7168, v56
  v_mfma_f32_16x16x32_bf16 v[172:175], v[132:135], a[36:39], v[172:175]
  ds_read_b64_tr_b16 v[158:159], v38 offset:53760
  buffer_load_dwordx4 a[144:147], v28, s[24:27], s66 offen
  v_add_u32 v58, 14336, v56
  v_mfma_f32_16x16x32_bf16 v[168:171], v[132:135], a[32:35], v[168:171]
  s_waitcnt lgkmcnt(10)
  ds_read_b128 a[48:51], v36 offset:12288
  v_add_u32 v59, 21504, v56
  v_and_b32 v9, 15, v1
  v_mfma_f32_16x16x32_bf16 v[176:179], a[32:35], v[136:139], v[176:179]
  ds_read_b128 a[52:55], v36 offset:12544
  ds_read_b64_tr_b16 v[128:129], v44 offset:40960
  v_lshrrev_b32 v11, 4, v1
  v_mfma_f32_16x16x32_bf16 v[184:187], a[36:39], v[136:139], v[184:187]
  ds_read_b64_tr_b16 v[130:131], v44 offset:41472
  buffer_load_dwordx4 a[148:151], v43, s[24:27], s66 offen
  v_lshlrev_b32 v11, 4, v11
  v_mfma_f32_16x16x32_bf16 v[188:191], a[36:39], v[140:143], v[188:191]
  s_xor_b32 s60, s39, 3
  ds_read_b64_tr_b16 v[132:133], v38 offset:40960
  v_lshl_add_u32 v253, v9, 10, v11
  v_lshlrev_b32 v9, 4, v9
  v_mfma_f32_16x16x32_bf16 v[180:183], a[32:35], v[140:143], v[180:183]
  s_waitcnt lgkmcnt(9)
  ds_read_b64_tr_b16 v[134:135], v38 offset:41472
  s_mul_i32 s60, s60, 393216
  s_add_u32 s60, s60, s58
  v_mfma_f32_16x16x32_bf16 v[160:163], v[144:147], a[40:43], v[160:163]
  s_add_u32 m0, s59, 65536
  ds_read_b64_tr_b16 v[136:137], v44 offset:57344
  ds_read_b64_tr_b16 v[138:139], v44 offset:57856
  s_add_u32 s60, s60, 1024
  v_mfma_f32_16x16x32_bf16 v[164:167], v[144:147], a[44:47], v[164:167]
  ds_read_b64_tr_b16 v[140:141], v38 offset:57344
  buffer_load_dwordx4 v29, s[8:11], s60 offen offset:0  lds
  v_lshl_add_u32 v9, v47, 8, v9
  v_mfma_f32_16x16x32_bf16 v[172:175], v[148:151], a[44:47], v[172:175]
  ds_read_b64_tr_b16 v[142:143], v38 offset:57856
  buffer_load_dwordx4 v30, s[8:11], s60 offen offset:1024  lds
  v_lshl_add_u32 v7, v14, 14, v9
  v_mfma_f32_16x16x32_bf16 v[168:171], v[148:151], a[40:43], v[168:171]
  s_waitcnt lgkmcnt(10)
  ds_read_b128 a[56:59], v37 offset:14336
  s_and_b32 s63, s36, 1
  s_lshl_b32 s85, s63, 10
  v_mfma_f32_16x16x32_bf16 v[176:179], a[40:43], v[152:155], v[176:179]
  s_add_u32 s85, s85, s62
  ds_read_b128 a[60:63], v37 offset:14592
  ds_read_b64_tr_b16 v[144:145], v44 offset:45056
  v_lshrrev_b32 v9, 1, v12
  v_mfma_f32_16x16x32_bf16 v[184:187], a[44:47], v[152:155], v[184:187]
  ds_read_b64_tr_b16 v[146:147], v44 offset:45568
  buffer_load_dwordx4 v31, s[8:11], s60 offen offset:2048  lds
  v_xor_b32 v9, v9, v12
  v_mfma_f32_16x16x32_bf16 v[188:191], a[44:47], v[156:159], v[188:191]
  ds_read_b64_tr_b16 v[148:149], v38 offset:45056
  v_and_b32 v9, 1, v9
  v_mul_u32_u24 v9, 192, v9
  v_mfma_f32_16x16x32_bf16 v[180:183], a[40:43], v[156:159], v[180:183]
  s_waitcnt lgkmcnt(9)
  ds_read_b64_tr_b16 v[150:151], v38 offset:45568
  buffer_load_dwordx4 v32, s[8:11], s60 offen offset:3072  lds
  v_xor_b32 v9, v9, v2
  v_mfma_f32_16x16x32_bf16 v[160:163], v[128:131], a[48:51], v[160:163]
  s_add_u32 m0, s59, 81920
  ds_read_b64_tr_b16 v[152:153], v44 offset:61440
  ds_read_b64_tr_b16 v[154:155], v44 offset:61952
  v_add_u32 v6, s85, v9
  v_mfma_f32_16x16x32_bf16 v[164:167], v[128:131], a[52:55], v[164:167]
  s_add_u32 s60, s60, 1024
  ds_read_b64_tr_b16 v[156:157], v38 offset:61440
  v_cmp_eq_u32 s[76:77], 0, v14
  s_add_u32 s85, s62, 4096
  v_mfma_f32_16x16x32_bf16 v[172:175], v[132:135], a[52:55], v[172:175]
  ds_read_b64_tr_b16 v[158:159], v38 offset:61952
  buffer_load_dwordx4 v29, s[8:11], s60 offen offset:0  lds
  v_mov_b32 v9, s85
  v_mfma_f32_16x16x32_bf16 v[168:171], v[132:135], a[48:51], v[168:171]
  s_waitcnt lgkmcnt(10)
  ds_read_b128 a[64:67], v36 offset:16384
  s_lshl_b32 s85, s63, 8
  s_add_u32 s85, s85, s62
  v_mfma_f32_16x16x32_bf16 v[176:179], a[48:51], v[136:139], v[176:179]
  s_add_u32 s85, s85, 2048
  s_waitcnt vmcnt(8) lgkmcnt(0)
  s_barrier
  ds_read_b128 a[68:71], v36 offset:16640
  v_add_u32 v11, s85, v2
  v_mfma_f32_16x16x32_bf16 v[184:187], a[52:55], v[136:139], v[184:187]
  ds_read_b64_tr_b16 v[128:129], v45 offset:0
  buffer_load_dwordx4 v30, s[8:11], s60 offen offset:1024  lds
  v_cndmask_b32 v4, v9, v11, s[76:77]
  v_mfma_f32_16x16x32_bf16 v[188:191], a[52:55], v[140:143], v[188:191]
  ds_read_b64_tr_b16 v[130:131], v45 offset:512
  ds_read_b64_tr_b16 v[132:133], v39 offset:0
  v_add_u32 v11, 1024, v11
  v_mfma_f32_16x16x32_bf16 v[180:183], a[48:51], v[140:143], v[180:183]
  ds_read_b64_tr_b16 v[134:135], v39 offset:512
  buffer_load_dwordx4 v31, s[8:11], s60 offen offset:2048  lds
  v_cndmask_b32 v5, v9, v11, s[76:77]
  v_mfma_f32_16x16x32_bf16 v[160:163], v[144:147], a[56:59], v[160:163]
  s_lshl_b32 s48, s45, 7
  ds_read_b64_tr_b16 v[136:137], v45 offset:16384
  ds_read_b64_tr_b16 v[138:139], v45 offset:16896
  s_lshl_b32 s62, s36, 17
  v_mfma_f32_16x16x32_bf16 v[164:167], v[144:147], a[60:63], v[164:167]
  s_add_u32 s48, s48, s62
  ds_read_b64_tr_b16 v[140:141], v39 offset:16384
  v_sub_u32 v9, 1, v252
  v_lshlrev_b32 v9, 4, v9
  v_mfma_f32_16x16x32_bf16 v[172:175], v[148:151], a[60:63], v[172:175]
  s_mov_b32 s76, -1
  ds_read_b64_tr_b16 v[142:143], v39 offset:16896
  buffer_load_dwordx4 v32, s[8:11], s60 offen offset:3072  lds
  s_mov_b32 s77, 0
  v_mfma_f32_16x16x32_bf16 v[168:171], v[148:151], a[56:59], v[168:171]
  s_lshl_b32 s61, s59, 1
  ds_read_b128 a[72:75], v37 offset:18432
  v_add_u32 v11, 0, v9
  v_med3_i32 v11, v11, 0, 32
  v_mfma_f32_16x16x32_bf16 v[176:179], a[56:59], v[152:155], v[176:179]
  s_add_u32 m0, s61, 98304
  ds_read_b128 a[76:79], v37 offset:18688
  ds_read_b64_tr_b16 v[144:145], v45 offset:4096
  v_lshrrev_b64 v[10:11], v11, s[76:77]
  v_mfma_f32_16x16x32_bf16 v[184:187], a[60:63], v[152:155], v[184:187]
  s_xor_b32 s60, s56, 0
  ds_read_b64_tr_b16 v[146:147], v45 offset:4608
  s_mul_i32 s60, s60, 196608
  s_add_u32 s60, s60, s57
  v_mfma_f32_16x16x32_bf16 v[188:191], a[60:63], v[156:159], v[188:191]
  ds_read_b64_tr_b16 v[148:149], v39 offset:4096
  buffer_load_dwordx4 v29, s[8:11], s60 offen offset:0  lds
  v_mov_b32 v16, v10
  v_mfma_f32_16x16x32_bf16 v[180:183], a[56:59], v[156:159], v[180:183]
  s_waitcnt lgkmcnt(9)
  ds_read_b64_tr_b16 v[150:151], v39 offset:4608
  buffer_load_dwordx4 v30, s[8:11], s60 offen offset:1024  lds
  v_add_u32 v11, 32, v9
  v_mfma_f32_16x16x32_bf16 v[160:163], v[128:131], a[64:67], v[160:163]
  ds_read_b64_tr_b16 v[152:153], v45 offset:20480
  ds_read_b64_tr_b16 v[154:155], v45 offset:20992
  v_med3_i32 v11, v11, 0, 32
  v_mfma_f32_16x16x32_bf16 v[164:167], v[128:131], a[68:71], v[164:167]
  ds_read_b64_tr_b16 v[156:157], v39 offset:20480
  v_lshrrev_b64 v[10:11], v11, s[76:77]
  v_mov_b32 v17, v10
  v_mfma_f32_16x16x32_bf16 v[172:175], v[132:135], a[68:71], v[172:175]
  ds_read_b64_tr_b16 v[158:159], v39 offset:20992
  buffer_load_dwordx4 v31, s[8:11], s60 offen offset:2048  lds
  v_add_u32 v11, 64, v9
  v_mfma_f32_16x16x32_bf16 v[168:171], v[132:135], a[64:67], v[168:171]
  s_waitcnt lgkmcnt(10)
  ds_read_b128 a[80:83], v36 offset:20480
  v_med3_i32 v11, v11, 0, 32
  v_lshrrev_b64 v[10:11], v11, s[76:77]
  v_mfma_f32_16x16x32_bf16 v[176:179], a[64:67], v[136:139], v[176:179]
  ds_read_b128 a[84:87], v36 offset:20736
  ds_read_b64_tr_b16 v[128:129], v45 offset:8192
  v_mov_b32 v18, v10
  v_mfma_f32_16x16x32_bf16 v[184:187], a[68:71], v[136:139], v[184:187]
  ds_read_b64_tr_b16 v[130:131], v45 offset:8704
  buffer_load_dwordx4 v32, s[8:11], s60 offen offset:3072  lds
  v_add_u32 v11, 96, v9
  v_mfma_f32_16x16x32_bf16 v[188:191], a[68:71], v[140:143], v[188:191]
  s_add_u32 m0, s61, 102400
  ds_read_b64_tr_b16 v[132:133], v39 offset:8192
  v_med3_i32 v11, v11, 0, 32
  v_lshrrev_b64 v[10:11], v11, s[76:77]
  v_mfma_f32_16x16x32_bf16 v[180:183], a[64:67], v[140:143], v[180:183]
  s_waitcnt lgkmcnt(9)
  ds_read_b64_tr_b16 v[134:135], v39 offset:8704
  s_add_u32 s60, s60, 98304
  buffer_load_dwordx4 v29, s[8:11], s60 offen offset:0  lds
  v_mfma_f32_16x16x32_bf16 v[160:163], v[144:147], a[72:75], v[160:163]
  ds_read_b64_tr_b16 v[136:137], v45 offset:24576
  ds_read_b64_tr_b16 v[138:139], v45 offset:25088
  v_mov_b32 v19, v10
  v_mfma_f32_16x16x32_bf16 v[164:167], v[144:147], a[76:79], v[164:167]
  ds_read_b64_tr_b16 v[140:141], v39 offset:24576
  v_add_u32 v11, 256, v9
  v_med3_i32 v11, v11, 0, 32
  v_mfma_f32_16x16x32_bf16 v[172:175], v[148:151], a[76:79], v[172:175]
  ds_read_b64_tr_b16 v[142:143], v39 offset:25088
  buffer_load_dwordx4 v30, s[8:11], s60 offen offset:1024  lds
  v_lshrrev_b64 v[10:11], v11, s[76:77]
  v_mfma_f32_16x16x32_bf16 v[168:171], v[148:151], a[72:75], v[168:171]
  s_waitcnt lgkmcnt(10)
  ds_read_b128 a[88:91], v37 offset:22528
  v_mov_b32 v20, v10
  v_add_u32 v11, 288, v9
  v_mfma_f32_16x16x32_bf16 v[176:179], a[72:75], v[152:155], v[176:179]
  ds_read_b128 a[92:95], v37 offset:22784
  ds_read_b64_tr_b16 v[144:145], v45 offset:12288
  v_med3_i32 v11, v11, 0, 32
  v_mfma_f32_16x16x32_bf16 v[184:187], a[76:79], v[152:155], v[184:187]
  ds_read_b64_tr_b16 v[146:147], v45 offset:12800
  buffer_load_dwordx4 v31, s[8:11], s60 offen offset:2048  lds
  v_lshrrev_b64 v[10:11], v11, s[76:77]
  v_mfma_f32_16x16x32_bf16 v[188:191], a[76:79], v[156:159], v[188:191]
  ds_read_b64_tr_b16 v[148:149], v39 offset:12288
  v_mov_b32 v21, v10
  v_add_u32 v11, 320, v9
  v_mfma_f32_16x16x32_bf16 v[180:183], a[72:75], v[156:159], v[180:183]
  s_waitcnt lgkmcnt(9)
  ds_read_b64_tr_b16 v[150:151], v39 offset:12800
  buffer_load_dwordx4 v32, s[8:11], s60 offen offset:3072  lds
  v_med3_i32 v11, v11, 0, 32
  v_mfma_f32_16x16x32_bf16 v[160:163], v[128:131], a[80:83], v[160:163]
  ds_read_b64_tr_b16 v[152:153], v45 offset:28672
  ds_read_b64_tr_b16 v[154:155], v45 offset:29184
  v_lshrrev_b64 v[10:11], v11, s[76:77]
  v_mfma_f32_16x16x32_bf16 v[164:167], v[128:131], a[84:87], v[164:167]
  ds_read_b64_tr_b16 v[156:157], v39 offset:28672
  v_mov_b32 v22, v10
  v_add_u32 v11, 352, v9
  v_mfma_f32_16x16x32_bf16 v[172:175], v[132:135], a[84:87], v[172:175]
  ds_read_b64_tr_b16 v[158:159], v39 offset:29184
  v_med3_i32 v11, v11, 0, 32
  v_lshrrev_b64 v[10:11], v11, s[76:77]
  v_mfma_f32_16x16x32_bf16 v[168:171], v[132:135], a[80:83], v[168:171]
  s_waitcnt lgkmcnt(10)
  ds_read_b128 a[96:99], v36 offset:24576
  v_mov_b32 v23, v10
  v_mov_b32 v224, v15
  v_mfma_f32_16x16x32_bf16 v[176:179], a[80:83], v[136:139], v[176:179]
  s_waitcnt vmcnt(8) lgkmcnt(0)
  s_barrier
  ds_read_b128 a[100:103], v36 offset:24832
  v_mov_b32 v225, v15
  v_mfma_f32_16x16x32_bf16 v[184:187], a[84:87], v[136:139], v[184:187]
  s_lshl_b32 s61, s59, 1
  ds_read_b64_tr_b16 v[128:129], v44 offset:0
  v_mov_b32 v226, v15
  v_mov_b32 v227, v15
  v_mfma_f32_16x16x32_bf16 v[188:191], a[84:87], v[140:143], v[188:191]
  s_add_u32 m0, s61, 131072
  ds_read_b64_tr_b16 v[130:131], v44 offset:512
  ds_read_b64_tr_b16 v[132:133], v38 offset:0
  s_xor_b32 s60, s56, 4
  v_mfma_f32_16x16x32_bf16 v[180:183], a[80:83], v[140:143], v[180:183]
  s_mul_i32 s60, s60, 196608
  ds_read_b64_tr_b16 v[134:135], v38 offset:512
  s_add_u32 s60, s60, s57
  buffer_load_dwordx4 v29, s[8:11], s60 offen offset:0  lds
  v_mfma_f32_16x16x32_bf16 v[160:163], v[144:147], a[88:91], v[160:163]
  s_mov_b64 s[20:21], s[12:13]
  ds_read_b64_tr_b16 v[136:137], v44 offset:16384
  ds_read_b64_tr_b16 v[138:139], v44 offset:16896
  s_mov_b32 s22, s74
  v_mfma_f32_16x16x32_bf16 v[164:167], v[144:147], a[92:95], v[164:167]
  s_mov_b64 s[24:25], s[68:69]
  ds_read_b64_tr_b16 v[140:141], v38 offset:16384
  buffer_load_dwordx4 v30, s[8:11], s60 offen offset:1024  lds
  s_mov_b32 s26, 0x80000
  v_mfma_f32_16x16x32_bf16 v[172:175], v[148:151], a[92:95], v[172:175]
  ds_read_b64_tr_b16 v[142:143], v38 offset:16896
  v_cmp_le_u32 s[76:77], 10, v1
  v_subrev_u32 v9, 10, v1
  v_mfma_f32_16x16x32_bf16 v[168:171], v[148:151], a[88:91], v[168:171]
  s_lshl_b32 s62, s37, 1
  ds_read_b128 a[104:107], v37 offset:26624
  buffer_load_dwordx4 v31, s[8:11], s60 offen offset:2048  lds
  v_cndmask_b32 v9, v1, v9, s[76:77]
  v_mfma_f32_16x16x32_bf16 v[176:179], a[88:91], v[152:155], v[176:179]
  ds_read_b128 a[108:111], v37 offset:26880
  ds_read_b64_tr_b16 v[144:145], v44 offset:4096
  v_add_u32 v9, s62, v9
  v_mfma_f32_16x16x32_bf16 v[184:187], a[92:95], v[152:155], v[184:187]
  ds_read_b64_tr_b16 v[146:147], v44 offset:4608
  v_cmp_le_u32 s[76:77], 8, v9
  v_min_u32 v9, 19, v1
  v_mfma_f32_16x16x32_bf16 v[188:191], a[92:95], v[156:159], v[188:191]
  ds_read_b64_tr_b16 v[148:149], v38 offset:4096
  buffer_load_dwordx4 v32, s[8:11], s60 offen offset:3072  lds
  v_mul_u32_u24 v116, 4112, v9
  v_mfma_f32_16x16x32_bf16 v[180:183], a[88:91], v[156:159], v[180:183]
  s_waitcnt lgkmcnt(9)
  ds_read_b64_tr_b16 v[150:151], v38 offset:4608
  v_cndmask_b32 v112, 0, v15, s[76:77]
  v_cndmask_b32 v113, 0, v15, s[76:77]
  v_mfma_f32_16x16x32_bf16 v[160:163], v[128:131], a[96:99], v[160:163]
  s_add_u32 m0, s61, 135168
  ds_read_b64_tr_b16 v[152:153], v44 offset:20480
  ds_read_b64_tr_b16 v[154:155], v44 offset:20992
  v_cndmask_b32 v114, 0, v15, s[76:77]
  v_mfma_f32_16x16x32_bf16 v[164:167], v[128:131], a[100:103], v[164:167]
  s_add_u32 s60, s60, 98304
  ds_read_b64_tr_b16 v[156:157], v38 offset:20480
  buffer_load_dwordx4 v29, s[8:11], s60 offen offset:0  lds
  v_cndmask_b32 v115, 0, v15, s[76:77]
  v_mfma_f32_16x16x32_bf16 v[172:175], v[132:135], a[100:103], v[172:175]
  s_lshl_b32 s62, s36, 9
  ds_read_b64_tr_b16 v[158:159], v38 offset:20992
  s_add_u32 s62, s62, 82432
  v_lshlrev_b32 v117, 2, v46
  v_mfma_f32_16x16x32_bf16 v[168:171], v[132:135], a[96:99], v[168:171]
  s_waitcnt lgkmcnt(10)
  ds_read_b128 a[112:115], v36 offset:28672
  buffer_load_dwordx4 v30, s[8:11], s60 offen offset:1024  lds
  v_add_u32 v118, s62, v117
  v_mfma_f32_16x16x32_bf16 v[176:179], a[96:99], v[136:139], v[176:179]
  s_lshl_b32 s62, s36, 7
  ds_read_b128 a[116:119], v36 offset:28928
  ds_read_b64_tr_b16 v[128:129], v44 offset:8192
  s_add_u32 s62, s62, 82432
  v_mfma_f32_16x16x32_bf16 v[184:187], a[100:103], v[136:139], v[184:187]
  ds_read_b64_tr_b16 v[130:131], v44 offset:8704
  v_add_u32 v119, s62, v117
  v_mov_b32 v10, 2130706432
  v_mfma_f32_16x16x32_bf16 v[188:191], a[100:103], v[140:143], v[188:191]
  ds_read_b64_tr_b16 v[132:133], v38 offset:8192
  buffer_load_dwordx4 v31, s[8:11], s60 offen offset:2048  lds
  v_mov_b32 v40, v10
  v_mfma_f32_16x16x32_bf16 v[180:183], a[96:99], v[140:143], v[180:183]
  s_waitcnt lgkmcnt(9)
  ds_read_b64_tr_b16 v[134:135], v38 offset:8704
  s_lshl2_add_u32 s62, s67, s47
  s_add_u32 s62, s62, 896
  v_mfma_f32_16x16x32_bf16 v[160:163], v[144:147], a[104:107], v[160:163]
  s_lshl_b32 s62, s62, 7
  ds_read_b64_tr_b16 v[136:137], v44 offset:24576
  ds_read_b64_tr_b16 v[138:139], v44 offset:25088
  v_writelane_b32 v40, s62, 0
  v_mfma_f32_16x16x32_bf16 v[164:167], v[144:147], a[108:111], v[164:167]
  s_lshl2_add_u32 s62, s73, s71
  ds_read_b64_tr_b16 v[140:141], v38 offset:24576
  buffer_load_dword v254, v33, s[32:35], 0 offen sc1
  s_add_u32 s62, s62, 1008
  v_mfma_f32_16x16x32_bf16 v[172:175], v[148:151], a[108:111], v[172:175]
  s_lshl_b32 s62, s62, 7
  ds_read_b64_tr_b16 v[142:143], v38 offset:25088
  v_writelane_b32 v40, s62, 1
  v_mfma_f32_16x16x32_bf16 v[168:171], v[148:151], a[104:107], v[168:171]
  s_waitcnt lgkmcnt(10)
  ds_read_b128 a[120:123], v37 offset:30720
  buffer_load_dwordx4 v32, s[8:11], s60 offen offset:3072  lds
  v_mfma_f32_16x16x32_bf16 v[176:179], a[104:107], v[152:155], v[176:179]
  ds_read_b128 a[124:127], v37 offset:30976
  ds_read_b64_tr_b16 v[144:145], v44 offset:12288
  v_mfma_f32_16x16x32_bf16 v[184:187], a[108:111], v[152:155], v[184:187]
  ds_read_b64_tr_b16 v[146:147], v44 offset:12800
  v_mfma_f32_16x16x32_bf16 v[188:191], a[108:111], v[156:159], v[188:191]
  ds_read_b64_tr_b16 v[148:149], v38 offset:12288
  v_mfma_f32_16x16x32_bf16 v[180:183], a[104:107], v[156:159], v[180:183]
  s_waitcnt lgkmcnt(9)
  ds_read_b64_tr_b16 v[150:151], v38 offset:12800
  v_mfma_f32_16x16x32_bf16 v[160:163], v[128:131], a[112:115], v[160:163]
  ds_read_b64_tr_b16 v[152:153], v44 offset:28672
  v_mfma_f32_16x16x32_bf16 v[164:167], v[128:131], a[116:119], v[164:167]
  ds_read_b64_tr_b16 v[154:155], v44 offset:29184
  v_mfma_f32_16x16x32_bf16 v[172:175], v[132:135], a[116:119], v[172:175]
  ds_read_b64_tr_b16 v[156:157], v38 offset:28672
  v_mfma_f32_16x16x32_bf16 v[168:171], v[132:135], a[112:115], v[168:171]
  s_waitcnt lgkmcnt(9)
  ds_read_b64_tr_b16 v[158:159], v38 offset:29184
  v_mfma_f32_16x16x32_bf16 v[176:179], a[112:115], v[136:139], v[176:179]
  s_cmp_gt_u32 s37, 0
  s_cselect_b32 s63, 0, 2130706432
  s_cselect_b32 s62, 131072, s92
  v_mfma_f32_16x16x32_bf16 v[184:187], a[116:119], v[136:139], v[184:187]
  v_add_u32 v96, s63, v2
  s_sub_u32 s16, s92, s62
  v_mfma_f32_16x16x32_bf16 v[188:191], a[116:119], v[140:143], v[188:191]
  s_cmp_gt_u32 s37, 1
  s_cselect_b32 s63, 0, 2130706432
  s_cselect_b32 s62, 262144, s92
  v_mfma_f32_16x16x32_bf16 v[180:183], a[112:115], v[140:143], v[180:183]
  s_waitcnt lgkmcnt(4)
  v_add_u32 v97, s63, v2
  s_sub_u32 s17, s92, s62
  v_mfma_f32_16x16x32_bf16 v[160:163], v[144:147], a[120:123], v[160:163]
  s_cmp_gt_u32 s37, 2
  s_cselect_b32 s63, 0, 2130706432
  s_cselect_b32 s62, 393216, s92
  v_mfma_f32_16x16x32_bf16 v[164:167], v[144:147], a[124:127], v[164:167]
  v_add_u32 v98, s63, v2
  s_sub_u32 s18, s92, s62
  v_mfma_f32_16x16x32_bf16 v[172:175], v[148:151], a[124:127], v[172:175]
  s_cmp_gt_u32 s37, 3
  s_cselect_b32 s63, 0, 2130706432
  s_cselect_b32 s62, 524288, s92
  v_mfma_f32_16x16x32_bf16 v[168:171], v[148:151], a[120:123], v[168:171]
  s_waitcnt lgkmcnt(0)
  v_add_u32 v99, s63, v2
  s_sub_u32 s19, s92, s62
  s_mov_b32 s61, s93
  v_mfma_f32_16x16x32_bf16 v[176:179], a[120:123], v[152:155], v[176:179]
  s_mov_b32 s0, s87
  s_mov_b32 s1, s90
  s_mov_b32 s59, s88
  s_mul_i32 s62, s43, 7
  v_mfma_f32_16x16x32_bf16 v[184:187], a[124:127], v[152:155], v[184:187]
  s_add_u32 s63, s62, 6
  s_lshr_b32 s62, s62, 2
  s_lshr_b32 s63, s63, 2
  v_cmp_gt_u32 s[76:77], 3, v1
  v_mfma_f32_16x16x32_bf16 v[188:191], a[124:127], v[156:159], v[188:191]
  v_add_u32 v11, s62, v1
  v_min_u32 v11, s63, v11
  s_add_u32 s62, s36, 896
  v_mfma_f32_16x16x32_bf16 v[180:183], a[120:123], v[156:159], v[180:183]
  s_lshl_b32 s62, s62, 7
  v_lshl_add_u32 v11, v11, 9, s62
  v_cndmask_b32 v8, v10, v11, s[76:77]
  v_cndmask_b32 v41, 0, 8, s[76:77]
  s_lshl_b32 s62, s45, 2
  s_add_u32 s62, s62, s36
  s_add_u32 s62, s62, 1008
  s_lshl_b32 s62, s62, 7
  v_writelane_b32 v8, s62, 3
  v_writelane_b32 v41, 28, 3
  v_cvt_pk_bf16_f32 v208, v160, v161
  v_cvt_pk_bf16_f32 v209, v162, v163
  v_cvt_pk_bf16_f32 v210, v164, v165
  v_cvt_pk_bf16_f32 v211, v166, v167
  v_cvt_pk_bf16_f32 v212, v168, v169
  v_cvt_pk_bf16_f32 v213, v170, v171
  v_cvt_pk_bf16_f32 v214, v172, v173
  v_cvt_pk_bf16_f32 v215, v174, v175
  v_permlane16_swap_b32 v208, v210
  v_permlane16_swap_b32 v209, v211
  v_permlane16_swap_b32 v212, v214
  v_permlane16_swap_b32 v213, v215
  buffer_store_dwordx4 v[208:211], v2, s[12:15], s92 offen offset:0 sc1
  buffer_store_dwordx4 v[212:215], v2, s[12:15], s92 offen offset:1024 sc1
  v_cvt_pk_bf16_f32 v216, v176, v177
  v_cvt_pk_bf16_f32 v217, v178, v179
  v_cvt_pk_bf16_f32 v218, v180, v181
  v_cvt_pk_bf16_f32 v219, v182, v183
  v_cvt_pk_bf16_f32 v220, v184, v185
  v_cvt_pk_bf16_f32 v221, v186, v187
  v_cvt_pk_bf16_f32 v222, v188, v189
  v_cvt_pk_bf16_f32 v223, v190, v191
  v_permlane16_swap_b32 v216, v218
  v_permlane16_swap_b32 v217, v219
  v_permlane16_swap_b32 v220, v222
  v_permlane16_swap_b32 v221, v223
  buffer_store_dwordx4 v[216:219], v2, s[12:15], s92 offen offset:2048 sc1
  buffer_store_dwordx4 v[220:223], v2, s[12:15], s92 offen offset:3072 sc1
  s_waitcnt vmcnt(13)
  s_barrier
  ds_read_b64_tr_b16 v[128:129], v44 offset:32768
  ds_read_b64_tr_b16 v[130:131], v44 offset:33280
  ds_read_b64_tr_b16 v[132:133], v38 offset:32768
  ds_read_b64_tr_b16 v[134:135], v38 offset:33280
  ds_read_b64_tr_b16 v[136:137], v44 offset:36864
  ds_read_b64_tr_b16 v[138:139], v44 offset:37376
  ds_read_b64_tr_b16 v[140:141], v38 offset:36864
  ds_read_b64_tr_b16 v[142:143], v38 offset:37376
  ds_read_b64_tr_b16 v[144:145], v44 offset:40960
  ds_read_b64_tr_b16 v[146:147], v44 offset:41472
  ds_read_b64_tr_b16 v[148:149], v38 offset:40960
  ds_read_b64_tr_b16 v[150:151], v38 offset:41472
  s_waitcnt lgkmcnt(10)
  v_mfma_f32_16x16x32_bf16 v[192:195], v[128:131], a[0:3], 0
  s_add_u32 s62, s37, s36
  ds_read_b64_tr_b16 v[152:153], v44 offset:45056
  ds_write_b128 v63, a[128:131] offset:0
  v_mfma_f32_16x16x32_bf16 v[196:199], v[128:131], a[4:7], 0
  ds_read_b64_tr_b16 v[154:155], v44 offset:45568
  s_sub_u32 s62, s62, 4
  s_cselect_b32 s3, 0, 4
  s_cselect_b32 s62, 0, s62
  s_waitcnt lgkmcnt(11)
  v_mfma_f32_16x16x32_bf16 v[204:207], v[132:135], a[4:7], 0
  s_lshl_b32 s47, s62, 3
  ds_read_b64_tr_b16 v[156:157], v38 offset:45056
  ds_write_b128 v63, a[132:135] offset:1536
  v_mfma_f32_16x16x32_bf16 v[200:203], v[132:135], a[0:3], 0
  s_waitcnt lgkmcnt(9)
  ds_read_b64_tr_b16 v[158:159], v38 offset:45568
  s_add_u32 s47, s47, s38
  s_lshl_b32 s47, s47, 7
  v_mov_b32 v27, 0
  v_mfma_f32_16x16x32_bf16 v[192:195], v[136:139], a[8:11], v[192:195]
  s_lshr_b32 s62, s36, 1
  ds_read_b64_tr_b16 v[128:129], v44 offset:49152
  ds_write_b128 v63, a[136:139] offset:4128
  v_mfma_f32_16x16x32_bf16 v[196:199], v[136:139], a[12:15], v[196:199]
  s_and_b32 s63, s36, 1
  ds_read_b64_tr_b16 v[130:131], v44 offset:49664
  s_lshl2_add_u32 s58, s44, s63
  s_lshl_b32 s58, s58, 8
  s_lshl1_add_u32 s85, s45, s62
  v_mfma_f32_16x16x32_bf16 v[204:207], v[140:143], a[12:15], v[204:207]
  s_add_u32 s58, s58, s85
  ds_read_b64_tr_b16 v[132:133], v38 offset:49152
  s_lshl_b32 s58, s58, 6
  s_add_u32 s40, s58, 32768
  s_lshl_b32 s56, s36, 14
  v_mfma_f32_16x16x32_bf16 v[200:203], v[140:143], a[8:11], v[200:203]
  s_waitcnt lgkmcnt(10)
  ds_read_b64_tr_b16 v[134:135], v38 offset:49664
  ds_write_b128 v63, a[140:143] offset:5664
  v_mfma_f32_16x16x32_bf16 v[192:195], v[144:147], a[16:19], v[192:195]
  ds_read_b64_tr_b16 v[136:137], v44 offset:53248
  v_lshrrev_b32 v9, 1, v12
  v_xor_b32 v9, s62, v9
  v_lshlrev_b32 v9, 6, v9
  v_mfma_f32_16x16x32_bf16 v[196:199], v[144:147], a[20:23], v[196:199]
  ds_read_b64_tr_b16 v[138:139], v44 offset:53760
  ds_write_b128 v63, a[144:147] offset:41120
  v_mfma_f32_16x16x32_bf16 v[204:207], v[148:151], a[20:23], v[204:207]
  ds_read_b64_tr_b16 v[140:141], v38 offset:53248
  v_lshl_add_u32 v9, v13, 4, v9
  v_lshl_add_u32 v9, v12, 7, v9
  v_lshl_add_u32 v9, v14, 9, v9
  v_mfma_f32_16x16x32_bf16 v[200:203], v[148:151], a[16:19], v[200:203]
  s_waitcnt lgkmcnt(10)
  ds_read_b64_tr_b16 v[142:143], v38 offset:53760
  ds_write_b128 v63, a[148:151] offset:42656
  s_waitcnt vmcnt(5)
  v_readfirstlane_b32 s99, v254
  s_nop 0
  s_cmp_lt_u32 s99, 33
  s_cbranch_scc1 L_spin1
L_back1:
  s_waitcnt vmcnt(0)
  buffer_atomic_add v34, v33, s[12:15], s70 offen sc1
  v_mfma_f32_16x16x32_bf16 v[192:195], v[152:155], a[24:27], v[192:195]
  ds_read_b64_tr_b16 v[144:145], v44 offset:57344
  v_lshl_add_u32 v9, v47, 11, v9
  v_add_u32 v31, 98304, v9
  s_lshl_b32 s85, s36, 11
  v_mfma_f32_16x16x32_bf16 v[196:199], v[152:155], a[28:31], v[196:199]
  s_add_u32 s85, s85, 86016
  ds_read_b64_tr_b16 v[146:147], v44 offset:57856
  ds_read_b64_tr_b16 v[228:229], v60 offset:0
  ds_read_b64_tr_b16 v[230:231], v60 offset:768
  ds_read_b64_tr_b16 v[232:233], v60 offset:32
  v_mfma_f32_16x16x32_bf16 v[204:207], v[156:159], a[28:31], v[204:207]
  ds_read_b64_tr_b16 v[148:149], v38 offset:57344
  ds_read_b64_tr_b16 v[234:235], v60 offset:800
  ds_read_b64_tr_b16 v[236:237], v60 offset:64
  ds_read_b64_tr_b16 v[238:239], v60 offset:832
  v_mfma_f32_16x16x32_bf16 v[200:203], v[156:159], a[24:27], v[200:203]
  s_waitcnt lgkmcnt(15)
  ds_read_b64_tr_b16 v[150:151], v38 offset:57856
  ds_read_b64_tr_b16 v[240:241], v60 offset:96
  ds_read_b64_tr_b16 v[242:243], v60 offset:864
  ds_read_b64_tr_b16 v[244:245], v61 offset:41120
  v_mfma_f32_16x16x32_bf16 v[192:195], v[128:131], a[32:35], v[192:195]
  ds_read_b64_tr_b16 v[152:153], v44 offset:61440
  ds_read_b64_tr_b16 v[246:247], v61 offset:41888
  ds_read_b64_tr_b16 v[248:249], v61 offset:41184
  ds_read_b64_tr_b16 v[250:251], v61 offset:41952
  v_mfma_f32_16x16x32_bf16 v[196:199], v[128:131], a[36:39], v[196:199]
  ds_read_b64_tr_b16 v[154:155], v44 offset:61952
  v_add_u32 v29, s85, v2
  s_lshl2_add_u32 s85, s62, s63
  s_lshl_b32 s85, s85, 10
  v_mfma_f32_16x16x32_bf16 v[204:207], v[132:135], a[36:39], v[204:207]
  s_add_u32 s85, s85, 86016
  ds_read_b64_tr_b16 v[156:157], v38 offset:61440
  v_add_u32 v30, s85, v2
  s_mul_i32 s50, s43, 229376
  s_lshl_b32 s51, s36, 13
  v_mfma_f32_16x16x32_bf16 v[200:203], v[132:135], a[32:35], v[200:203]
  s_waitcnt lgkmcnt(15)
  ds_read_b64_tr_b16 v[158:159], v38 offset:61952
  s_add_u32 s50, s50, s51
  s_add_u32 s50, s50, 17825792
  s_lshl2_add_u32 s49, s45, s36
  s_waitcnt lgkmcnt(3)
  v_mfma_f32_32x32x16_bf16 v[64:79], v[224:227], v[228:231], 0
  s_mul_i32 s49, s49, 57344
  ds_write_b128 v3, v[208:211] offset:32896
  s_add_u32 s49, s49, 22020096
  s_lshl2_add_u32 s52, s38, s36
  s_lshl_b32 s52, s52, 9
  v_mfma_f32_32x32x16_bf16 v[80:95], v[224:227], v[232:235], 0
  s_lshl_b32 s85, s37, 16
  ds_write_b128 v3, v[212:215] offset:33920
  buffer_store_dwordx4 v[228:231], v62, s[20:23], s0 offen sc1
  s_add_u32 s52, s52, s85
  v_mfma_f32_32x32x16_bf16 v[160:175], v[224:227], v[236:239], 0
  s_add_u32 s0, s0, 32768
  s_add_u32 s52, s52, 5242880
  s_add_u32 s41, s52, 32768
  s_lshr_b32 s85, s38, 1
  s_lshl3_add_u32 s53, s37, s85
  s_add_u32 s53, s53, 256
  s_lshl_b32 s53, s53, 7
  v_mfma_f32_32x32x16_bf16 v[176:191], v[224:227], v[240:243], 0
  s_lshl3_add_u32 s54, s44, s36
  buffer_store_dwordx4 v[232:235], v62, s[20:23], s0 offen sc1
  s_add_u32 s54, s54, 256
  s_lshl_b32 s54, s54, 7
  s_lshl4_add_u32 s55, s44, s36
  s_lshl_b32 s55, s55, 12
  v_mfma_f32_16x16x32_bf16 v[192:195], v[136:139], a[40:43], v[192:195]
  s_add_u32 s0, s0, 32768
  s_waitcnt lgkmcnt(0)
  s_barrier
  ds_read_b64_tr_b16 v[128:129], v45 offset:0
  s_add_u32 s55, s55, 5242880
  v_mfma_f32_16x16x32_bf16 v[196:199], v[136:139], a[44:47], v[196:199]
  ds_read_b64_tr_b16 v[130:131], v45 offset:512
  ds_write_b128 v3, v[216:219] offset:34944
  v_mfma_f32_16x16x32_bf16 v[204:207], v[140:143], a[44:47], v[204:207]
  ds_read_b64_tr_b16 v[132:133], v39 offset:0
  buffer_store_dwordx4 v[236:239], v62, s[20:23], s0 offen sc1
  v_mfma_f32_16x16x32_bf16 v[200:203], v[140:143], a[40:43], v[200:203]
  s_add_u32 s0, s0, 32768
  ds_read_b64_tr_b16 v[134:135], v39 offset:512
  ds_write_b32 v118, v64 offset:0
  ds_write_b32 v118, v80 offset:128
  buffer_store_dwordx4 v[240:243], v62, s[20:23], s0 offen sc1
  v_mfma_f32_16x16x32_bf16 v[192:195], v[144:147], a[48:51], v[192:195]
  ds_read_b64_tr_b16 v[136:137], v45 offset:4096
  ds_write_b32 v118, v160 offset:256
  v_mfma_f32_16x16x32_bf16 v[196:199], v[144:147], a[52:55], v[196:199]
  ds_read_b64_tr_b16 v[138:139], v45 offset:4608
  ds_write_b32 v118, v176 offset:384
  buffer_store_dwordx4 v[244:247], v62, s[20:23], s1 offen offset:0 sc1
  v_mfma_f32_16x16x32_bf16 v[204:207], v[148:151], a[52:55], v[204:207]
  ds_read_b64_tr_b16 v[140:141], v39 offset:4096
  ds_write_b128 v3, v[220:223] offset:35968
  v_mfma_f32_16x16x32_bf16 v[200:203], v[148:151], a[48:51], v[200:203]
  ds_read_b64_tr_b16 v[142:143], v39 offset:4608
  buffer_store_dwordx4 v[248:251], v62, s[20:23], s1 offen offset:2048 sc1
  v_mfma_f32_16x16x32_bf16 v[192:195], v[152:155], a[56:59], v[192:195]
  ds_read_b64_tr_b16 v[144:145], v45 offset:8192
  ds_write_b128 v116, v[112:115] offset:4096
  v_mfma_f32_16x16x32_bf16 v[196:199], v[152:155], a[60:63], v[196:199]
  ds_read_b64_tr_b16 v[146:147], v45 offset:8704
  v_mfma_f32_16x16x32_bf16 v[204:207], v[156:159], a[60:63], v[204:207]
  ds_read_b64_tr_b16 v[148:149], v39 offset:8192
  v_mfma_f32_16x16x32_bf16 v[200:203], v[156:159], a[56:59], v[200:203]
  s_waitcnt lgkmcnt(13)
  ds_read_b64_tr_b16 v[150:151], v39 offset:8704
  v_mfma_f32_16x16x32_bf16 v[192:195], v[128:131], a[64:67], v[192:195]
  ds_read_b64_tr_b16 v[152:153], v45 offset:12288
  buffer_atomic_add v27, v33, s[12:15], s47 offen sc0 sc1
  v_mfma_f32_16x16x32_bf16 v[196:199], v[128:131], a[68:71], v[196:199]
  ds_read_b64_tr_b16 v[154:155], v45 offset:12800
  v_mfma_f32_16x16x32_bf16 v[204:207], v[132:135], a[68:71], v[204:207]
  ds_read_b64_tr_b16 v[156:157], v39 offset:12288
  v_mfma_f32_16x16x32_bf16 v[200:203], v[132:135], a[64:67], v[200:203]
  s_waitcnt lgkmcnt(8)
  ds_read_b64_tr_b16 v[158:159], v39 offset:12800
  v_mfma_f32_16x16x32_bf16 v[192:195], v[136:139], a[72:75], v[192:195]
  ds_read_b64_tr_b16 v[128:129], v45 offset:16384
  v_mfma_f32_16x16x32_bf16 v[196:199], v[136:139], a[76:79], v[196:199]
  ds_read_b64_tr_b16 v[130:131], v45 offset:16896
  v_mfma_f32_16x16x32_bf16 v[204:207], v[140:143], a[76:79], v[204:207]
  ds_read_b64_tr_b16 v[132:133], v39 offset:16384
  v_mfma_f32_16x16x32_bf16 v[200:203], v[140:143], a[72:75], v[200:203]
  s_waitcnt lgkmcnt(7)
  ds_read_b64_tr_b16 v[134:135], v39 offset:16896
  v_mfma_f32_16x16x32_bf16 v[192:195], v[144:147], a[80:83], v[192:195]
  ds_read_b64_tr_b16 v[136:137], v45 offset:20480
  v_mfma_f32_16x16x32_bf16 v[196:199], v[144:147], a[84:87], v[196:199]
  ds_read_b64_tr_b16 v[138:139], v45 offset:20992
  v_mfma_f32_16x16x32_bf16 v[204:207], v[148:151], a[84:87], v[204:207]
  ds_read_b64_tr_b16 v[140:141], v39 offset:20480
  v_mfma_f32_16x16x32_bf16 v[200:203], v[148:151], a[80:83], v[200:203]
  s_waitcnt lgkmcnt(7)
  ds_read_b64_tr_b16 v[142:143], v39 offset:20992
  v_mfma_f32_16x16x32_bf16 v[192:195], v[152:155], a[88:91], v[192:195]
  ds_read_b64_tr_b16 v[144:145], v45 offset:24576
  v_mfma_f32_16x16x32_bf16 v[196:199], v[152:155], a[92:95], v[196:199]
  ds_read_b64_tr_b16 v[146:147], v45 offset:25088
  v_mfma_f32_16x16x32_bf16 v[204:207], v[156:159], a[92:95], v[204:207]
  ds_read_b64_tr_b16 v[148:149], v39 offset:24576
  v_mfma_f32_16x16x32_bf16 v[200:203], v[156:159], a[88:91], v[200:203]
  s_waitcnt lgkmcnt(7)
  ds_read_b64_tr_b16 v[150:151], v39 offset:25088
  v_mfma_f32_16x16x32_bf16 v[192:195], v[128:131], a[96:99], v[192:195]
  ds_read_b64_tr_b16 v[152:153], v45 offset:28672
  v_mfma_f32_16x16x32_bf16 v[196:199], v[128:131], a[100:103], v[196:199]
  ds_read_b64_tr_b16 v[154:155], v45 offset:29184
  v_mfma_f32_16x16x32_bf16 v[204:207], v[132:135], a[100:103], v[204:207]
  ds_read_b64_tr_b16 v[156:157], v39 offset:28672
  v_mfma_f32_16x16x32_bf16 v[200:203], v[132:135], a[96:99], v[200:203]
  s_waitcnt lgkmcnt(7)
  ds_read_b64_tr_b16 v[158:159], v39 offset:29184
  v_mfma_f32_16x16x32_bf16 v[192:195], v[136:139], a[104:107], v[192:195]
  v_mfma_f32_16x16x32_bf16 v[196:199], v[136:139], a[108:111], v[196:199]
  v_mfma_f32_16x16x32_bf16 v[204:207], v[140:143], a[108:111], v[204:207]
  v_mfma_f32_16x16x32_bf16 v[200:203], v[140:143], a[104:107], v[200:203]
  s_waitcnt lgkmcnt(4)
  v_mfma_f32_16x16x32_bf16 v[192:195], v[144:147], a[112:115], v[192:195]
  v_mfma_f32_16x16x32_bf16 v[196:199], v[144:147], a[116:119], v[196:199]
  v_mfma_f32_16x16x32_bf16 v[204:207], v[148:151], a[116:119], v[204:207]
  v_mfma_f32_16x16x32_bf16 v[200:203], v[148:151], a[112:115], v[200:203]
  s_waitcnt lgkmcnt(0)
  v_mfma_f32_16x16x32_bf16 v[192:195], v[152:155], a[120:123], v[192:195]
  v_mfma_f32_16x16x32_bf16 v[196:199], v[152:155], a[124:127], v[196:199]
  v_mfma_f32_16x16x32_bf16 v[204:207], v[156:159], a[124:127], v[204:207]
  v_mfma_f32_16x16x32_bf16 v[200:203], v[156:159], a[120:123], v[200:203]
  s_mov_b32 s63, 0x3eb8aa3b
  s_nop 3
  v_mul_f32 v192, s63, v192
  v_mul_f32 v193, s63, v193
  v_mul_f32 v194, s63, v194
  v_mul_f32 v195, s63, v195
  v_mul_f32 v196, s63, v196
  v_mul_f32 v197, s63, v197
  v_mul_f32 v198, s63, v198
  v_mul_f32 v199, s63, v199
  v_mul_f32 v200, s63, v200
  v_mul_f32 v201, s63, v201
  v_mul_f32 v202, s63, v202
  v_mul_f32 v203, s63, v203
  v_mul_f32 v204, s63, v204
  v_mul_f32 v205, s63, v205
  v_mul_f32 v206, s63, v206
  v_mul_f32 v207, s63, v207
  v_cvt_pk_bf16_f32 v48, v192, v193
  v_cvt_pk_bf16_f32 v49, v194, v195
  v_cvt_pk_bf16_f32 v50, v196, v197
  v_cvt_pk_bf16_f32 v51, v198, v199
  v_cvt_pk_bf16_f32 v52, v200, v201
  v_cvt_pk_bf16_f32 v53, v202, v203
  v_cvt_pk_bf16_f32 v54, v204, v205
  v_cvt_pk_bf16_f32 v55, v206, v207
  v_permlane16_swap_b32 v48, v50
  v_permlane16_swap_b32 v49, v51
  v_permlane16_swap_b32 v52, v54
  v_permlane16_swap_b32 v53, v55
  ds_write_b128 v29, v[48:51] offset:0
  ds_write_b128 v29, v[52:55] offset:1024
  s_waitcnt vmcnt(0)
  v_readfirstlane_b32 s99, v27
  s_nop 0
  s_cmp_lt_u32 s99, s3
  s_cbranch_scc1 L_spin2
L_back2:
  s_waitcnt lgkmcnt(0)
  s_barrier
  s_add_u32 m0, s61, 24672
  s_nop 0
  buffer_load_dwordx4 v96, s[12:15], s16 offen offset:0 sc1 lds
  buffer_load_dwordx4 v96, s[12:15], s16 offen offset:1024 sc1 lds
  buffer_load_dwordx4 v96, s[12:15], s16 offen offset:2048 sc1 lds
  buffer_load_dwordx4 v96, s[12:15], s16 offen offset:3072 sc1 lds
  ds_read_b32 v24, v119 offset:0
  ds_read_b32 v25, v119 offset:512
  ds_read_b32 v26, v119 offset:1024
  ds_read_b32 v27, v119 offset:1536
  s_add_u32 m0, s61, 16448
  s_nop 0
  buffer_load_dwordx4 v97, s[12:15], s17 offen offset:0 sc1 lds
  buffer_load_dwordx4 v97, s[12:15], s17 offen offset:1024 sc1 lds
  ds_read_b128 v[48:51], v30 offset:2048
  ds_read_b128 v[52:55], v30 offset:0
  ds_read_b128 v[144:147], v6 offset:37008
  ds_read_b128 v[148:151], v6 offset:32896
  ds_read_b128 v[160:163], v4 offset:37008
  ds_read_b128 v[164:167], v5 offset:37008
  s_waitcnt lgkmcnt(3)
  v_mfma_f32_32x32x16_bf16 v[64:79], v[144:147], v[48:51], 0
  buffer_load_dwordx4 v97, s[12:15], s17 offen offset:2048 sc1 lds
  v_add_f32 v26, v26, v27
  v_add_f32 v24, v24, v25
  v_add_f32 v24, v24, v26
  buffer_store_dword v24, v117, s[20:23], s59 offen sc1
  s_nop 6
  v_exp_f32 v64, v64
  v_exp_f32 v65, v65
  v_exp_f32 v66, v66
  v_exp_f32 v67, v67
  v_cvt_pk_bf16_f32 v112, v64, v65
  v_and_b32 v112, v16, v112
  v_exp_f32 v68, v68
  v_exp_f32 v69, v69
  v_cvt_pk_bf16_f32 v113, v66, v67
  v_and_b32 v113, v17, v113
  v_exp_f32 v70, v70
  v_exp_f32 v71, v71
  v_cvt_pk_bf16_f32 v114, v68, v69
  v_and_b32 v114, v18, v114
  s_waitcnt lgkmcnt(2)
  v_mfma_f32_32x32x16_bf16 v[80:95], v[148:151], v[48:51], 0
  ds_read_b128 v[168:171], v4 offset:32896
  ds_read_b128 v[172:175], v5 offset:32896
  buffer_load_dwordx4 v97, s[12:15], s17 offen offset:3072 sc1 lds
  v_exp_f32 v72, v72
  v_exp_f32 v73, v73
  v_cvt_pk_bf16_f32 v115, v70, v71
  v_and_b32 v115, v19, v115
  v_exp_f32 v74, v74
  v_exp_f32 v75, v75
  v_cvt_pk_bf16_f32 v116, v72, v73
  v_and_b32 v116, v20, v116
  s_waitcnt lgkmcnt(3)
  v_mfma_f32_32x32x16_bf16 v[192:207], v[160:163], v[112:115], 0
  s_add_u32 m0, s61, 8224
  ds_read_b128 v[152:155], v6 offset:32896
  buffer_load_dwordx4 v98, s[12:15], s18 offen offset:0 sc1 lds
  v_exp_f32 v76, v76
  v_exp_f32 v77, v77
  v_cvt_pk_bf16_f32 v117, v74, v75
  v_and_b32 v117, v21, v117
  v_exp_f32 v78, v78
  v_exp_f32 v79, v79
  v_cvt_pk_bf16_f32 v118, v76, v77
  v_and_b32 v118, v22, v118
  v_exp_f32 v80, v80
  v_exp_f32 v81, v81
  v_cvt_pk_bf16_f32 v119, v78, v79
  v_and_b32 v119, v23, v119
  v_exp_f32 v82, v82
  v_exp_f32 v83, v83
  v_cvt_pk_bf16_f32 v120, v80, v81
  s_waitcnt lgkmcnt(3)
  v_mfma_f32_32x32x16_bf16 v[192:207], v[164:167], v[116:119], v[192:207]
  s_waitcnt lgkmcnt(0)
  ds_read_b128 v[176:179], v4 offset:32896
  buffer_load_dwordx4 v98, s[12:15], s18 offen offset:1024 sc1 lds
  v_exp_f32 v84, v84
  v_exp_f32 v85, v85
  v_cvt_pk_bf16_f32 v121, v82, v83
  v_exp_f32 v86, v86
  v_exp_f32 v87, v87
  v_cvt_pk_bf16_f32 v122, v84, v85
  v_mfma_f32_32x32x16_bf16 v[64:79], v[152:155], v[52:55], 0
  ds_read_b128 v[180:183], v5 offset:32896
  buffer_load_dwordx4 v98, s[12:15], s18 offen offset:2048 sc1 lds
  v_exp_f32 v88, v88
  v_exp_f32 v89, v89
  v_cvt_pk_bf16_f32 v123, v86, v87
  v_exp_f32 v90, v90
  v_exp_f32 v91, v91
  v_cvt_pk_bf16_f32 v124, v88, v89
  v_mfma_f32_32x32x16_bf16 v[192:207], v[168:171], v[120:123], v[192:207]
  s_waitcnt vmcnt(8)
  s_barrier
  ds_read_b128 v[156:159], v6 offset:28784
  buffer_load_dwordx4 v98, s[12:15], s18 offen offset:3072 sc1 lds
  v_exp_f32 v92, v92
  v_exp_f32 v93, v93
  v_cvt_pk_bf16_f32 v125, v90, v91
  v_exp_f32 v94, v94
  v_exp_f32 v95, v95
  v_cvt_pk_bf16_f32 v126, v92, v93
  v_exp_f32 v64, v64
  v_exp_f32 v65, v65
  v_cvt_pk_bf16_f32 v127, v94, v95
  v_exp_f32 v66, v66
  v_exp_f32 v67, v67
  v_cvt_pk_bf16_f32 v112, v64, v65
  v_and_b32 v112, v16, v112
  v_mfma_f32_32x32x16_bf16 v[192:207], v[172:175], v[124:127], v[192:207]
  s_waitcnt lgkmcnt(0)
  ds_read_b128 v[184:187], v4 offset:28784
  s_add_u32 m0, s61, 0
  s_nop 0
  buffer_load_dwordx4 v99, s[12:15], s19 offen offset:0 sc1 lds
  v_exp_f32 v68, v68
  v_exp_f32 v69, v69
  v_cvt_pk_bf16_f32 v113, v66, v67
  v_and_b32 v113, v17, v113
  v_exp_f32 v70, v70
  v_exp_f32 v71, v71
  v_cvt_pk_bf16_f32 v114, v68, v69
  v_and_b32 v114, v18, v114
  v_mfma_f32_32x32x16_bf16 v[80:95], v[156:159], v[48:51], 0
  ds_read_b128 v[188:191], v5 offset:28784
  buffer_load_dwordx4 v99, s[12:15], s19 offen offset:1024 sc1 lds
  v_exp_f32 v72, v72
  v_exp_f32 v73, v73
  v_cvt_pk_bf16_f32 v115, v70, v71
  v_and_b32 v115, v19, v115
  v_exp_f32 v74, v74
  v_exp_f32 v75, v75
  v_cvt_pk_bf16_f32 v116, v72, v73
  v_and_b32 v116, v20, v116
  v_mfma_f32_32x32x16_bf16 v[208:223], v[176:179], v[112:115], 0
  ds_read_b128 v[144:147], v6 offset:24672
  buffer_load_dwordx4 v99, s[12:15], s19 offen offset:2048 sc1 lds
  v_exp_f32 v76, v76
  v_exp_f32 v77, v77
  v_cvt_pk_bf16_f32 v117, v74, v75
  v_and_b32 v117, v21, v117
  v_exp_f32 v78, v78
  v_exp_f32 v79, v79
  v_cvt_pk_bf16_f32 v118, v76, v77
  v_and_b32 v118, v22, v118
  v_exp_f32 v80, v80
  v_exp_f32 v81, v81
  v_cvt_pk_bf16_f32 v119, v78, v79
  v_and_b32 v119, v23, v119
  v_exp_f32 v82, v82
  v_exp_f32 v83, v83
  v_cvt_pk_bf16_f32 v120, v80, v81
  v_mfma_f32_32x32x16_bf16 v[208:223], v[180:183], v[116:119], v[208:223]
  s_waitcnt lgkmcnt(0)
  ds_read_b128 v[160:163], v4 offset:24672
  buffer_load_dwordx4 v99, s[12:15], s19 offen offset:3072 sc1 lds
  v_exp_f32 v84, v84
  v_exp_f32 v85, v85
  v_cvt_pk_bf16_f32 v121, v82, v83
  v_exp_f32 v86, v86
  v_exp_f32 v87, v87
  v_cvt_pk_bf16_f32 v122, v84, v85
  v_mfma_f32_32x32x16_bf16 v[64:79], v[144:147], v[48:51], 0
  ds_read_b128 v[164:167], v5 offset:24672
  buffer_load_dwordx4 v[128:131], v253, s[4:7], s40 offen
  v_exp_f32 v88, v88
  v_exp_f32 v89, v89
  v_cvt_pk_bf16_f32 v123, v86, v87
  v_exp_f32 v90, v90
  v_exp_f32 v91, v91
  v_cvt_pk_bf16_f32 v124, v88, v89
  v_mfma_f32_32x32x16_bf16 v[192:207], v[184:187], v[120:123], v[192:207]
  s_waitcnt vmcnt(9)
  s_barrier
  ds_read_b128 v[148:151], v6 offset:20560
  buffer_load_dwordx4 v[132:135], v253, s[4:7], s58 offen
  v_exp_f32 v92, v92
  v_exp_f32 v93, v93
  v_cvt_pk_bf16_f32 v125, v90, v91
  v_exp_f32 v94, v94
  v_exp_f32 v95, v95
  v_cvt_pk_bf16_f32 v126, v92, v93
  v_exp_f32 v64, v64
  v_exp_f32 v65, v65
  v_cvt_pk_bf16_f32 v127, v94, v95
  v_exp_f32 v66, v66
  v_exp_f32 v67, v67
  v_cvt_pk_bf16_f32 v112, v64, v65
  v_mfma_f32_32x32x16_bf16 v[192:207], v[188:191], v[124:127], v[192:207]
  s_waitcnt lgkmcnt(0)
  ds_read_b128 v[168:171], v4 offset:20560
  buffer_atomic_add v34, v40, s[20:23], 0 offen sc1
  s_add_u32 m0, s56, 98304
  s_add_u32 s57, s48, 0
  buffer_load_dwordx4 v56, s[24:27], s57 offen offset:0 lds
  v_exp_f32 v68, v68
  v_exp_f32 v69, v69
  v_cvt_pk_bf16_f32 v113, v66, v67
  v_exp_f32 v70, v70
  v_exp_f32 v71, v71
  v_cvt_pk_bf16_f32 v114, v68, v69
  v_mfma_f32_32x32x16_bf16 v[80:95], v[148:151], v[48:51], 0
  ds_read_b128 v[172:175], v5 offset:20560
  buffer_load_dwordx4 v57, s[24:27], s57 offen offset:1024 lds
  v_exp_f32 v72, v72
  v_exp_f32 v73, v73
  v_cvt_pk_bf16_f32 v115, v70, v71
  v_exp_f32 v74, v74
  v_exp_f32 v75, v75
  v_cvt_pk_bf16_f32 v116, v72, v73
  v_mfma_f32_32x32x16_bf16 v[192:207], v[160:163], v[112:115], v[192:207]
  ds_read_b128 v[152:155], v6 offset:16448
  buffer_load_dwordx4 v58, s[24:27], s57 offen offset:2048 lds
  v_exp_f32 v76, v76
  v_exp_f32 v77, v77
  v_cvt_pk_bf16_f32 v117, v74, v75
  v_exp_f32 v78, v78
  v_exp_f32 v79, v79
  v_cvt_pk_bf16_f32 v118, v76, v77
  v_exp_f32 v80, v80
  v_exp_f32 v81, v81
  v_cvt_pk_bf16_f32 v119, v78, v79
  v_exp_f32 v82, v82
  v_exp_f32 v83, v83
  v_cvt_pk_bf16_f32 v120, v80, v81
  v_mfma_f32_32x32x16_bf16 v[192:207], v[164:167], v[116:119], v[192:207]
  s_waitcnt lgkmcnt(0)
  ds_read_b128 v[176:179], v4 offset:16448
  buffer_load_dwordx4 v59, s[24:27], s57 offen offset:3072 lds
  v_exp_f32 v84, v84
  v_exp_f32 v85, v85
  v_cvt_pk_bf16_f32 v121, v82, v83
  v_exp_f32 v86, v86
  v_exp_f32 v87, v87
  v_cvt_pk_bf16_f32 v122, v84, v85
  v_mfma_f32_32x32x16_bf16 v[64:79], v[152:155], v[48:51], 0
  s_add_u32 m0, s56, 102400
  ds_read_b128 v[180:183], v5 offset:16448
  s_add_u32 s57, s48, 32768
  buffer_load_dwordx4 v56, s[24:27], s57 offen offset:0 lds
  v_exp_f32 v88, v88
  v_exp_f32 v89, v89
  v_cvt_pk_bf16_f32 v123, v86, v87
  v_exp_f32 v90, v90
  v_exp_f32 v91, v91
  v_cvt_pk_bf16_f32 v124, v88, v89
  v_mfma_f32_32x32x16_bf16 v[192:207], v[168:171], v[120:123], v[192:207]
  s_waitcnt vmcnt(12)
  s_barrier
  ds_read_b128 v[156:159], v6 offset:12336
  buffer_load_dwordx4 v57, s[24:27], s57 offen offset:1024 lds
  v_exp_f32 v92, v92
  v_exp_f32 v93, v93
  v_cvt_pk_bf16_f32 v125, v90, v91
  v_exp_f32 v94, v94
  v_exp_f32 v95, v95
  v_cvt_pk_bf16_f32 v126, v92, v93
  v_exp_f32 v64, v64
  v_exp_f32 v65, v65
  v_cvt_pk_bf16_f32 v127, v94, v95
  v_exp_f32 v66, v66
  v_exp_f32 v67, v67
  v_cvt_pk_bf16_f32 v112, v64, v65
  v_mfma_f32_32x32x16_bf16 v[192:207], v[172:175], v[124:127], v[192:207]
  s_waitcnt lgkmcnt(0)
  ds_read_b128 v[184:187], v4 offset:12336
  buffer_load_dwordx4 v58, s[24:27], s57 offen offset:2048 lds
  v_exp_f32 v68, v68
  v_exp_f32 v69, v69
  v_cvt_pk_bf16_f32 v113, v66, v67
  v_exp_f32 v70, v70
  v_exp_f32 v71, v71
  v_cvt_pk_bf16_f32 v114, v68, v69
  v_mfma_f32_32x32x16_bf16 v[80:95], v[156:159], v[48:51], 0
  ds_read_b128 v[188:191], v5 offset:12336
  buffer_load_dwordx4 v59, s[24:27], s57 offen offset:3072 lds
  v_exp_f32 v72, v72
  v_exp_f32 v73, v73
  v_cvt_pk_bf16_f32 v115, v70, v71
  v_exp_f32 v74, v74
  v_exp_f32 v75, v75
  v_cvt_pk_bf16_f32 v116, v72, v73
  v_mfma_f32_32x32x16_bf16 v[192:207], v[176:179], v[112:115], v[192:207]
  s_add_u32 m0, s56, 106496
  ds_read_b128 v[144:147], v6 offset:8224
  s_add_u32 s57, s48, 65536
  buffer_load_dwordx4 v56, s[24:27], s57 offen offset:0 lds
  v_exp_f32 v76, v76
  v_exp_f32 v77, v77
  v_cvt_pk_bf16_f32 v117, v74, v75
  v_exp_f32 v78, v78
  v_exp_f32 v79, v79
  v_cvt_pk_bf16_f32 v118, v76, v77
  v_exp_f32 v80, v80
  v_exp_f32 v81, v81
  v_cvt_pk_bf16_f32 v119, v78, v79
  v_exp_f32 v82, v82
  v_exp_f32 v83, v83
  v_cvt_pk_bf16_f32 v120, v80, v81
  v_mfma_f32_32x32x16_bf16 v[192:207], v[180:183], v[116:119], v[192:207]
  s_waitcnt lgkmcnt(0)
  ds_read_b128 v[160:163], v4 offset:8224
  buffer_load_dwordx4 v57, s[24:27], s57 offen offset:1024 lds
  v_exp_f32 v84, v84
  v_exp_f32 v85, v85
  v_cvt_pk_bf16_f32 v121, v82, v83
  v_exp_f32 v86, v86
  v_exp_f32 v87, v87
  v_cvt_pk_bf16_f32 v122, v84, v85
  v_mfma_f32_32x32x16_bf16 v[64:79], v[144:147], v[48:51], 0
  ds_read_b128 v[164:167], v5 offset:8224
  buffer_load_dwordx4 v58, s[24:27], s57 offen offset:2048 lds
  v_exp_f32 v88, v88
  v_exp_f32 v89, v89
  v_cvt_pk_bf16_f32 v123, v86, v87
  v_exp_f32 v90, v90
  v_exp_f32 v91, v91
  v_cvt_pk_bf16_f32 v124, v88, v89
  v_mfma_f32_32x32x16_bf16 v[192:207], v[184:187], v[120:123], v[192:207]
  s_waitcnt vmcnt(14)
  s_barrier
  ds_read_b128 v[148:151], v6 offset:4112
  buffer_load_dwordx4 v59, s[24:27], s57 offen offset:3072 lds
  v_exp_f32 v92, v92
  v_exp_f32 v93, v93
  v_cvt_pk_bf16_f32 v125, v90, v91
  v_exp_f32 v94, v94
  v_exp_f32 v95, v95
  v_cvt_pk_bf16_f32 v126, v92, v93
  v_exp_f32 v64, v64
  v_exp_f32 v65, v65
  v_cvt_pk_bf16_f32 v127, v94, v95
  v_exp_f32 v66, v66
  v_exp_f32 v67, v67
  v_cvt_pk_bf16_f32 v112, v64, v65
  v_mfma_f32_32x32x16_bf16 v[192:207], v[188:191], v[124:127], v[192:207]
  s_waitcnt lgkmcnt(0)
  ds_read_b128 v[168:171], v4 offset:4112
  s_add_u32 m0, s56, 110592
  s_add_u32 s57, s48, 98304
  buffer_load_dwordx4 v56, s[24:27], s57 offen offset:0 lds
  v_exp_f32 v68, v68
  v_exp_f32 v69, v69
  v_cvt_pk_bf16_f32 v113, v66, v67
  v_exp_f32 v70, v70
  v_exp_f32 v71, v71
  v_cvt_pk_bf16_f32 v114, v68, v69
  v_mfma_f32_32x32x16_bf16 v[80:95], v[148:151], v[48:51], 0
  ds_read_b128 v[172:175], v5 offset:4112
  buffer_load_dwordx4 v57, s[24:27], s57 offen offset:1024 lds
  v_exp_f32 v72, v72
  v_exp_f32 v73, v73
  v_cvt_pk_bf16_f32 v115, v70, v71
  v_exp_f32 v74, v74
  v_exp_f32 v75, v75
  v_cvt_pk_bf16_f32 v116, v72, v73
  v_mfma_f32_32x32x16_bf16 v[192:207], v[160:163], v[112:115], v[192:207]
  ds_read_b128 v[152:155], v6 offset:0
  buffer_load_dwordx4 v58, s[24:27], s57 offen offset:2048 lds
  v_exp_f32 v76, v76
  v_exp_f32 v77, v77
  v_cvt_pk_bf16_f32 v117, v74, v75
  v_exp_f32 v78, v78
  v_exp_f32 v79, v79
  v_cvt_pk_bf16_f32 v118, v76, v77
  v_mov_b32 v28, 0
  v_exp_f32 v80, v80
  v_exp_f32 v81, v81
  v_cvt_pk_bf16_f32 v119, v78, v79
  v_exp_f32 v82, v82
  v_exp_f32 v83, v83
  v_cvt_pk_bf16_f32 v120, v80, v81
  v_bfi_b32 v120, v16, 0, v120
  v_mfma_f32_32x32x16_bf16 v[192:207], v[164:167], v[116:119], v[192:207]
  s_waitcnt lgkmcnt(0)
  ds_read_b128 v[176:179], v4 offset:0
  buffer_atomic_add v28, v8, s[12:15], 0 offen sc0 sc1
  buffer_load_dwordx4 v59, s[24:27], s57 offen offset:3072 lds
  v_exp_f32 v84, v84
  v_exp_f32 v85, v85
  v_cvt_pk_bf16_f32 v121, v82, v83
  v_bfi_b32 v121, v17, 0, v121
  v_exp_f32 v86, v86
  v_exp_f32 v87, v87
  v_cvt_pk_bf16_f32 v122, v84, v85
  v_bfi_b32 v122, v18, 0, v122
  v_mfma_f32_32x32x16_bf16 v[64:79], v[152:155], v[52:55], 0
  ds_read_b128 v[180:183], v5 offset:0
  v_exp_f32 v88, v88
  v_exp_f32 v89, v89
  v_cvt_pk_bf16_f32 v123, v86, v87
  v_bfi_b32 v123, v19, 0, v123
  v_exp_f32 v90, v90
  v_exp_f32 v91, v91
  v_cvt_pk_bf16_f32 v124, v88, v89
  v_bfi_b32 v124, v20, 0, v124
  v_mfma_f32_32x32x16_bf16 v[192:207], v[168:171], v[120:123], v[192:207]
  ds_read_b128 v[156:159], v6 offset:28784
  v_exp_f32 v92, v92
  v_exp_f32 v93, v93
  v_cvt_pk_bf16_f32 v125, v90, v91
  v_bfi_b32 v125, v21, 0, v125
  v_exp_f32 v94, v94
  v_exp_f32 v95, v95
  v_cvt_pk_bf16_f32 v126, v92, v93
  v_bfi_b32 v126, v22, 0, v126
  v_exp_f32 v64, v64
  v_exp_f32 v65, v65
  v_cvt_pk_bf16_f32 v127, v94, v95
  v_bfi_b32 v127, v23, 0, v127
  v_exp_f32 v66, v66
  v_exp_f32 v67, v67
  v_cvt_pk_bf16_f32 v112, v64, v65
  v_bfi_b32 v112, v16, 0, v112
  v_mfma_f32_32x32x16_bf16 v[192:207], v[172:175], v[124:127], v[192:207]
  s_waitcnt lgkmcnt(0)
  ds_read_b128 v[184:187], v4 offset:28784
  v_exp_f32 v68, v68
  v_exp_f32 v69, v69
  v_cvt_pk_bf16_f32 v113, v66, v67
  v_bfi_b32 v113, v17, 0, v113
  v_exp_f32 v70, v70
  v_exp_f32 v71, v71
  v_cvt_pk_bf16_f32 v114, v68, v69
  v_bfi_b32 v114, v18, 0, v114
  v_mfma_f32_32x32x16_bf16 v[80:95], v[156:159], v[52:55], 0
  ds_read_b128 v[188:191], v5 offset:28784
  v_exp_f32 v72, v72
  v_exp_f32 v73, v73
  v_cvt_pk_bf16_f32 v115, v70, v71
  v_bfi_b32 v115, v19, 0, v115
  v_exp_f32 v74, v74
  v_exp_f32 v75, v75
  v_cvt_pk_bf16_f32 v116, v72, v73
  v_bfi_b32 v116, v20, 0, v116
  v_mfma_f32_32x32x16_bf16 v[208:223], v[176:179], v[112:115], v[208:223]
  ds_read_b128 v[144:147], v6 offset:24672
  v_exp_f32 v76, v76
  v_exp_f32 v77, v77
  v_cvt_pk_bf16_f32 v117, v74, v75
  v_bfi_b32 v117, v21, 0, v117
  v_exp_f32 v78, v78
  v_exp_f32 v79, v79
  v_cvt_pk_bf16_f32 v118, v76, v77
  v_bfi_b32 v118, v22, 0, v118
  v_exp_f32 v80, v80
  v_subrev_u32 v9, 0x1f800000, v200
  v_cmp_le_u32 vcc, 0x40000000, v9
  s_nop 0
  s_cmp_lg_u64 vcc, 0
  s_cselect_b32 s59, 2130706432, 0
  v_or_b32 v27, s59, v33
  v_rcp_f32 v11, v200
  s_nop 0
  v_mul_f32 v192, v192, v11
  v_mul_f32 v193, v193, v11
  v_mul_f32 v194, v194, v11
  v_mul_f32 v195, v195, v11
  v_mul_f32 v196, v196, v11
  v_mul_f32 v197, v197, v11
  v_mul_f32 v198, v198, v11
  v_mul_f32 v199, v199, v11
  v_cvt_pk_bf16_f32 v192, v192, v193
  v_cvt_pk_bf16_f32 v193, v194, v195
  v_cvt_pk_bf16_f32 v194, v196, v197
  v_cvt_pk_bf16_f32 v195, v198, v199
  v_exp_f32 v81, v81
  v_cvt_pk_bf16_f32 v119, v78, v79
  v_bfi_b32 v119, v23, 0, v119
  v_exp_f32 v82, v82
  v_exp_f32 v83, v83
  v_cvt_pk_bf16_f32 v120, v80, v81
  v_mfma_f32_32x32x16_bf16 v[208:223], v[180:183], v[116:119], v[208:223]
  s_waitcnt lgkmcnt(0)
  ds_read_b128 v[160:163], v4 offset:24672
  buffer_store_dwordx4 v[192:195], v7, s[12:15], s41 offen sc1
  v_exp_f32 v84, v84
  v_exp_f32 v85, v85
  v_cvt_pk_bf16_f32 v121, v82, v83
  v_exp_f32 v86, v86
  v_exp_f32 v87, v87
  v_cvt_pk_bf16_f32 v122, v84, v85
  v_mfma_f32_32x32x16_bf16 v[64:79], v[144:147], v[52:55], 0
  ds_read_b128 v[164:167], v5 offset:24672
  v_exp_f32 v88, v88
  v_exp_f32 v89, v89
  v_cvt_pk_bf16_f32 v123, v86, v87
  v_exp_f32 v90, v90
  v_exp_f32 v91, v91
  v_cvt_pk_bf16_f32 v124, v88, v89
  v_mfma_f32_32x32x16_bf16 v[208:223], v[184:187], v[120:123], v[208:223]
  ds_read_b128 v[148:151], v6 offset:20560
  v_exp_f32 v92, v92
  v_exp_f32 v93, v93
  v_cvt_pk_bf16_f32 v125, v90, v91
  v_exp_f32 v94, v94
  v_exp_f32 v95, v95
  v_cvt_pk_bf16_f32 v126, v92, v93
  s_waitcnt vmcnt(2)
  v_cmp_gt_u32 vcc, v41, v28
  s_nop 0
  s_cmp_lg_u32 vcc_lo, 0
  s_cbranch_scc1 L_spin3
L_back3:
  v_exp_f32 v64, v64
  v_exp_f32 v65, v65
  v_cvt_pk_bf16_f32 v127, v94, v95
  v_exp_f32 v66, v66
  v_exp_f32 v67, v67
  v_cvt_pk_bf16_f32 v112, v64, v65
  v_mfma_f32_32x32x16_bf16 v[208:223], v[188:191], v[124:127], v[208:223]
  s_waitcnt lgkmcnt(0)
  ds_read_b128 v[168:171], v4 offset:20560
  s_add_u32 s57, s49, 0
  buffer_load_dwordx4 a[0:3], v2, s[12:15], s57 offen offset:0 sc1
  v_exp_f32 v68, v68
  v_exp_f32 v69, v69
  v_cvt_pk_bf16_f32 v113, v66, v67
  v_exp_f32 v70, v70
  v_exp_f32 v71, v71
  v_cvt_pk_bf16_f32 v114, v68, v69
  v_mfma_f32_32x32x16_bf16 v[80:95], v[148:151], v[52:55], 0
  ds_read_b128 v[172:175], v5 offset:20560
  buffer_load_dwordx4 a[4:7], v2, s[12:15], s57 offen offset:1024 sc1
  v_exp_f32 v72, v72
  v_exp_f32 v73, v73
  v_cvt_pk_bf16_f32 v115, v70, v71
  v_exp_f32 v74, v74
  v_exp_f32 v75, v75
  v_cvt_pk_bf16_f32 v116, v72, v73
  v_mfma_f32_32x32x16_bf16 v[208:223], v[160:163], v[112:115], v[208:223]
  ds_read_b128 v[152:155], v6 offset:16448
  buffer_load_dwordx4 a[8:11], v2, s[12:15], s57 offen offset:2048 sc1
  v_exp_f32 v76, v76
  v_exp_f32 v77, v77
  v_cvt_pk_bf16_f32 v117, v74, v75
  v_exp_f32 v78, v78
  v_exp_f32 v79, v79
  v_cvt_pk_bf16_f32 v118, v76, v77
  v_exp_f32 v80, v80
  v_exp_f32 v81, v81
  v_cvt_pk_bf16_f32 v119, v78, v79
  v_exp_f32 v82, v82
  v_exp_f32 v83, v83
  v_cvt_pk_bf16_f32 v120, v80, v81
  v_mfma_f32_32x32x16_bf16 v[208:223], v[164:167], v[116:119], v[208:223]
  s_waitcnt lgkmcnt(0)
  ds_read_b128 v[176:179], v4 offset:16448
  s_waitcnt vmcnt(3)
  buffer_atomic_add v34, v27, s[12:15], s53 offen offset:512 sc1
  buffer_load_dwordx4 a[12:15], v2, s[12:15], s57 offen offset:3072 sc1
  v_exp_f32 v84, v84
  v_exp_f32 v85, v85
  v_cvt_pk_bf16_f32 v121, v82, v83
  v_exp_f32 v86, v86
  v_exp_f32 v87, v87
  v_cvt_pk_bf16_f32 v122, v84, v85
  v_mfma_f32_32x32x16_bf16 v[64:79], v[152:155], v[52:55], 0
  s_add_u32 s57, s49, 4096
  ds_read_b128 v[180:183], v5 offset:16448
  buffer_load_dwordx4 a[16:19], v2, s[12:15], s57 offen offset:0 sc1
  v_exp_f32 v88, v88
  v_exp_f32 v89, v89
  v_cvt_pk_bf16_f32 v123, v86, v87
  v_exp_f32 v90, v90
  v_exp_f32 v91, v91
  v_cvt_pk_bf16_f32 v124, v88, v89
  v_mfma_f32_32x32x16_bf16 v[208:223], v[168:171], v[120:123], v[208:223]
  ds_read_b128 v[156:159], v6 offset:12336
  buffer_load_dwordx4 a[20:23], v2, s[12:15], s57 offen offset:1024 sc1
  v_exp_f32 v92, v92
  v_exp_f32 v93, v93
  v_cvt_pk_bf16_f32 v125, v90, v91
  v_exp_f32 v94, v94
  v_exp_f32 v95, v95
  v_cvt_pk_bf16_f32 v126, v92, v93
  v_exp_f32 v64, v64
  v_exp_f32 v65, v65
  v_cvt_pk_bf16_f32 v127, v94, v95
  v_exp_f32 v66, v66
  v_exp_f32 v67, v67
  v_cvt_pk_bf16_f32 v112, v64, v65
  v_mfma_f32_32x32x16_bf16 v[208:223], v[172:175], v[124:127], v[208:223]
  s_waitcnt lgkmcnt(0)
  ds_read_b128 v[184:187], v4 offset:12336
  buffer_load_dwordx4 a[24:27], v2, s[12:15], s57 offen offset:2048 sc1
  v_exp_f32 v68, v68
  v_exp_f32 v69, v69
  v_cvt_pk_bf16_f32 v113, v66, v67
  v_exp_f32 v70, v70
  v_exp_f32 v71, v71
  v_cvt_pk_bf16_f32 v114, v68, v69
  v_mfma_f32_32x32x16_bf16 v[80:95], v[156:159], v[52:55], 0
  ds_read_b128 v[188:191], v5 offset:12336
  buffer_load_dwordx4 a[28:31], v2, s[12:15], s57 offen offset:3072 sc1
  v_exp_f32 v72, v72
  v_exp_f32 v73, v73
  v_cvt_pk_bf16_f32 v115, v70, v71
  v_exp_f32 v74, v74
  v_exp_f32 v75, v75
  v_cvt_pk_bf16_f32 v116, v72, v73
  v_mfma_f32_32x32x16_bf16 v[208:223], v[176:179], v[112:115], v[208:223]
  s_add_u32 s57, s49, 8192
  ds_read_b128 v[144:147], v6 offset:8224
  buffer_load_dwordx4 a[32:35], v2, s[12:15], s57 offen offset:0 sc1
  v_exp_f32 v76, v76
  v_exp_f32 v77, v77
  v_cvt_pk_bf16_f32 v117, v74, v75
  v_exp_f32 v78, v78
  v_exp_f32 v79, v79
  v_cvt_pk_bf16_f32 v118, v76, v77
  v_mov_b32 v26, 0
  v_exp_f32 v80, v80
  v_exp_f32 v81, v81
  v_cvt_pk_bf16_f32 v119, v78, v79
  v_exp_f32 v82, v82
  v_exp_f32 v83, v83
  v_cvt_pk_bf16_f32 v120, v80, v81
  v_mfma_f32_32x32x16_bf16 v[208:223], v[180:183], v[116:119], v[208:223]
  s_waitcnt lgkmcnt(0)
  ds_read_b128 v[160:163], v4 offset:8224
  buffer_atomic_add v26, v33, s[12:15], s54 offen offset:512 sc0 sc1
  buffer_load_dwordx4 a[36:39], v2, s[12:15], s57 offen offset:1024 sc1
  v_exp_f32 v84, v84
  v_exp_f32 v85, v85
  v_cvt_pk_bf16_f32 v121, v82, v83
  v_exp_f32 v86, v86
  v_exp_f32 v87, v87
  v_cvt_pk_bf16_f32 v122, v84, v85
  v_mfma_f32_32x32x16_bf16 v[64:79], v[144:147], v[52:55], 0
  ds_read_b128 v[164:167], v5 offset:8224
  buffer_load_dwordx4 a[40:43], v2, s[12:15], s57 offen offset:2048 sc1
  v_exp_f32 v88, v88
  v_exp_f32 v89, v89
  v_cvt_pk_bf16_f32 v123, v86, v87
  v_exp_f32 v90, v90
  v_exp_f32 v91, v91
  v_cvt_pk_bf16_f32 v124, v88, v89
  v_mfma_f32_32x32x16_bf16 v[208:223], v[184:187], v[120:123], v[208:223]
  ds_read_b128 v[148:151], v6 offset:4112
  buffer_load_dwordx4 a[44:47], v2, s[12:15], s57 offen offset:3072 sc1
  v_exp_f32 v92, v92
  v_exp_f32 v93, v93
  v_cvt_pk_bf16_f32 v125, v90, v91
  v_exp_f32 v94, v94
  v_exp_f32 v95, v95
  v_cvt_pk_bf16_f32 v126, v92, v93
  v_exp_f32 v64, v64
  v_exp_f32 v65, v65
  v_cvt_pk_bf16_f32 v127, v94, v95
  v_exp_f32 v66, v66
  v_exp_f32 v67, v67
  v_cvt_pk_bf16_f32 v112, v64, v65
  v_mfma_f32_32x32x16_bf16 v[208:223], v[188:191], v[124:127], v[208:223]
  s_waitcnt lgkmcnt(0)
  ds_read_b128 v[168:171], v4 offset:4112
  s_add_u32 s57, s49, 12288
  buffer_load_dwordx4 a[48:51], v2, s[12:15], s57 offen offset:0 sc1
  v_exp_f32 v68, v68
  v_exp_f32 v69, v69
  v_cvt_pk_bf16_f32 v113, v66, v67
  v_exp_f32 v70, v70
  v_exp_f32 v71, v71
  v_cvt_pk_bf16_f32 v114, v68, v69
  v_mfma_f32_32x32x16_bf16 v[80:95], v[148:151], v[52:55], 0
  ds_read_b128 v[172:175], v5 offset:4112
  buffer_load_dwordx4 a[52:55], v2, s[12:15], s57 offen offset:1024 sc1
  v_exp_f32 v72, v72
  v_exp_f32 v73, v73
  v_cvt_pk_bf16_f32 v115, v70, v71
  v_exp_f32 v74, v74
  v_exp_f32 v75, v75
  v_cvt_pk_bf16_f32 v116, v72, v73
  v_mfma_f32_32x32x16_bf16 v[208:223], v[160:163], v[112:115], v[208:223]
  buffer_load_dwordx4 a[56:59], v2, s[12:15], s57 offen offset:2048 sc1
  v_exp_f32 v76, v76
  v_exp_f32 v77, v77
  v_cvt_pk_bf16_f32 v117, v74, v75
  v_exp_f32 v78, v78
  v_exp_f32 v79, v79
  v_cvt_pk_bf16_f32 v118, v76, v77
  v_exp_f32 v80, v80
  v_exp_f32 v81, v81
  v_cvt_pk_bf16_f32 v119, v78, v79
  v_exp_f32 v82, v82
  v_exp_f32 v83, v83
  v_cvt_pk_bf16_f32 v120, v80, v81
  v_mfma_f32_32x32x16_bf16 v[208:223], v[164:167], v[116:119], v[208:223]
  s_waitcnt lgkmcnt(0)
  buffer_load_dwordx4 a[60:63], v2, s[12:15], s57 offen offset:3072 sc1
  v_exp_f32 v84, v84
  v_exp_f32 v85, v85
  v_cvt_pk_bf16_f32 v121, v82, v83
  v_exp_f32 v86, v86
  v_exp_f32 v87, v87
  v_cvt_pk_bf16_f32 v122, v84, v85
  v_exp_f32 v88, v88
  v_exp_f32 v89, v89
  v_cvt_pk_bf16_f32 v123, v86, v87
  v_exp_f32 v90, v90
  v_exp_f32 v91, v91
  v_cvt_pk_bf16_f32 v124, v88, v89
  v_mfma_f32_32x32x16_bf16 v[208:223], v[168:171], v[120:123], v[208:223]
  s_add_u32 s57, s49, 16384
  buffer_load_dwordx4 a[64:67], v2, s[12:15], s57 offen offset:0 sc1
  v_exp_f32 v92, v92
  v_exp_f32 v93, v93
  v_cvt_pk_bf16_f32 v125, v90, v91
  v_exp_f32 v94, v94
  v_exp_f32 v95, v95
  v_cvt_pk_bf16_f32 v126, v92, v93
  v_cvt_pk_bf16_f32 v127, v94, v95
  s_nop 1
  v_mfma_f32_32x32x16_bf16 v[208:223], v[172:175], v[124:127], v[208:223]
  buffer_load_dwordx4 a[68:71], v2, s[12:15], s57 offen offset:1024 sc1
  s_nop 10
  v_subrev_u32 v9, 0x1f800000, v216
  v_cmp_le_u32 vcc, 0x40000000, v9
  s_nop 0
  s_cmp_lg_u64 vcc, 0
  s_cselect_b32 s62, 1, s59
  s_cmp_lg_u32 s62, 0
  s_cbranch_scc1 L_safe
L_attdone:
  v_rcp_f32 v11, v216
  s_nop 0
  v_mul_f32 v208, v208, v11
  v_mul_f32 v209, v209, v11
  v_mul_f32 v210, v210, v11
  v_mul_f32 v211, v211, v11
  v_mul_f32 v212, v212, v11
  v_mul_f32 v213, v213, v11
  v_mul_f32 v214, v214, v11
  v_mul_f32 v215, v215, v11
  v_cvt_pk_bf16_f32 v208, v208, v209
  v_cvt_pk_bf16_f32 v209, v210, v211
  v_cvt_pk_bf16_f32 v210, v212, v213
  v_cvt_pk_bf16_f32 v211, v214, v215
  buffer_store_dwordx4 v[208:211], v7, s[12:15], s52 offen sc1
  s_add_u32 s87, s54, 512
  s_lshr_b32 s86, s51, 1
  s_waitcnt vmcnt(10)
  v_readfirstlane_b32 s99, v26
  s_nop 0
  s_cmp_lt_u32 s99, 8
  s_cbranch_scc1 L_spin4
L_back4:
  s_barrier
  s_add_u32 m0, s86, 65536
  s_add_u32 s60, s55, 32768
  buffer_load_dwordx4 v2, s[12:15], s60 offen offset:0 sc1 lds
  buffer_load_dwordx4 v2, s[12:15], s60 offen offset:1024 sc1 lds
  v_mov_b32 v46, v253
  v_lshlrev_b32 v96, 16, v128
  v_and_b32 v97, 0xffff0000, v128
  v_lshlrev_b32 v98, 16, v129
  v_and_b32 v99, 0xffff0000, v129
  v_lshlrev_b32 v100, 16, v130
  v_and_b32 v101, 0xffff0000, v130
  v_lshlrev_b32 v102, 16, v131
  v_and_b32 v103, 0xffff0000, v131
  v_lshlrev_b32 v104, 16, v132
  v_and_b32 v105, 0xffff0000, v132
  v_lshlrev_b32 v106, 16, v133
  v_and_b32 v107, 0xffff0000, v133
  v_lshlrev_b32 v108, 16, v134
  v_and_b32 v109, 0xffff0000, v134
  v_lshlrev_b32 v110, 16, v135
  v_and_b32 v111, 0xffff0000, v135
  s_add_u32 m0, s86, 81920
  s_add_u32 s60, s55, 49152
  buffer_load_dwordx4 v2, s[12:15], s60 offen offset:0 sc1 lds
  ds_read_b64_tr_b16 v[128:129], v31 offset:0
  ds_read_b64_tr_b16 v[130:131], v31 offset:1024
  ds_read_b64_tr_b16 v[132:133], v31 offset:8
  ds_read_b64_tr_b16 v[134:135], v31 offset:1032
  s_lshr_b32 s62, s36, 1
  s_and_b32 s63, s36, 1
  s_lshl1_add_u32 s81, s45, s62
  s_lshl_b32 s83, s44, 5
  s_add_u32 s81, s81, s83
  s_lshl1_add_u32 s83, s81, s63
  buffer_load_dwordx4 v2, s[12:15], s60 offen offset:1024 sc1 lds
  ds_read_b64_tr_b16 v[136:137], v31 offset:4096
  ds_read_b64_tr_b16 v[138:139], v31 offset:5120
  ds_read_b64_tr_b16 v[140:141], v31 offset:4104
  ds_read_b64_tr_b16 v[142:143], v31 offset:5128
  s_lshl_b32 s83, s83, 7
  s_add_u32 s83, s83, 24641536
  s_add_u32 s82, s83, 4096
  s_lshl2_add_u32 s81, s44, s63
  s_lshl3_add_u32 s81, s81, s45
  s_lshl1_add_u32 s81, s81, s62
  s_add_u32 m0, s86, 65536
  s_add_u32 s60, s55, 32768
  buffer_load_dwordx4 v2, s[12:15], s60 offen offset:2048 sc1 lds
  ds_read_b64_tr_b16 v[144:145], v31 offset:8192
  ds_read_b64_tr_b16 v[146:147], v31 offset:9216
  ds_read_b64_tr_b16 v[148:149], v31 offset:8200
  ds_read_b64_tr_b16 v[150:151], v31 offset:9224
  s_lshl_b32 s81, s81, 10
  s_add_u32 s81, s81, 7340032
  s_add_u32 s80, s81, 32768
  s_add_u32 s58, s54, 32768
  s_lshl_b32 s62, s63, 14
  s_add_u32 s62, s62, 65536
  buffer_load_dwordx4 v2, s[12:15], s60 offen offset:3072 sc1 lds
  ds_read_b64_tr_b16 v[152:153], v31 offset:12288
  ds_read_b64_tr_b16 v[154:155], v31 offset:13312
  ds_read_b64_tr_b16 v[156:157], v31 offset:12296
  ds_read_b64_tr_b16 v[158:159], v31 offset:13320
  s_waitcnt vmcnt(6)
  buffer_atomic_add v34, v33, s[12:15], s53 offen offset:0 sc1
  v_add_u32 v120, s62, v2
  v_add_u32 v124, 65536, v120
  v_and_b32 v9, 15, v1
  v_lshlrev_b32 v9, 2, v9
  v_lshl_add_u32 v123, v47, 6, v9
  s_lshr_b32 s62, s36, 1
  s_add_u32 m0, s86, 81920
  s_add_u32 s60, s55, 49152
  buffer_load_dwordx4 v2, s[12:15], s60 offen offset:2048 sc1 lds
  ds_read_b64_tr_b16 v[160:161], v31 offset:16384
  ds_read_b64_tr_b16 v[162:163], v31 offset:17408
  ds_read_b64_tr_b16 v[164:165], v31 offset:16392
  ds_read_b64_tr_b16 v[166:167], v31 offset:17416
  s_and_b32 s63, s36, 1
  s_lshl1_add_u32 s47, s42, s62
  s_lshl3_add_u32 s76, s47, s63
  s_add_u32 s76, s76, 512
  s_lshl_b32 s76, s76, 7
  s_add_u32 s89, s76, 512
  buffer_load_dwordx4 v2, s[12:15], s60 offen offset:3072 sc1 lds
  ds_read_b64_tr_b16 v[168:169], v31 offset:20480
  ds_read_b64_tr_b16 v[170:171], v31 offset:21504
  ds_read_b64_tr_b16 v[172:173], v31 offset:20488
  ds_read_b64_tr_b16 v[174:175], v31 offset:21512
  s_lshl_b32 s75, s47, 6
  s_add_u32 s75, s75, s63
  s_lshl_b32 s75, s75, 7
  s_add_u32 s75, s75, 24641536
  s_lshl2_add_u32 s64, s47, s63
  s_lshl_b32 s77, s64, 14
  s_add_u32 m0, s51, 0
  s_add_u32 s60, s50, 0
  buffer_load_dwordx4 v2, s[12:15], s60 offen offset:0 sc1 lds
  ds_read_b64_tr_b16 v[176:177], v31 offset:24576
  ds_read_b64_tr_b16 v[178:179], v31 offset:25600
  ds_read_b64_tr_b16 v[180:181], v31 offset:24584
  ds_read_b64_tr_b16 v[182:183], v31 offset:25608
  s_add_u32 s77, s77, 7340032
  v_and_b32 v25, 15, v1
  v_lshlrev_b32 v26, 4, v25
  v_lshl_add_u32 v26, v47, 8, v26
  v_bfe_u32 v10, v1, 4, 1
  v_xor_b32 v10, 1, v10
  buffer_load_dwordx4 v2, s[12:15], s60 offen offset:1024 sc1 lds
  ds_read_b64_tr_b16 v[184:185], v31 offset:28672
  ds_read_b64_tr_b16 v[186:187], v31 offset:29696
  ds_read_b64_tr_b16 v[188:189], v31 offset:28680
  ds_read_b64_tr_b16 v[190:191], v31 offset:29704
  v_mul_u32_u24 v27, 114688, v10
  v_add_u32 v7, v26, v27
  s_mul_i32 s64, s64, 56
  s_lshr_b32 s63, s43, 1
  s_mul_i32 s63, s63, 7
  s_add_u32 s64, s64, s63
  buffer_load_dwordx4 v2, s[12:15], s60 offen offset:2048 sc1 lds
  ds_read_b64_tr_b16 v[192:193], v31 offset:32768
  ds_read_b64_tr_b16 v[194:195], v31 offset:33792
  ds_read_b64_tr_b16 v[196:197], v31 offset:32776
  ds_read_b64_tr_b16 v[198:199], v31 offset:33800
  s_and_b32 s63, s43, 1
  s_lshl1_add_u32 s64, s64, s63
  s_lshl_b32 s64, s64, 9
  s_add_u32 s64, s64, 9437184
  s_add_u32 s65, s64, 4096
  s_lshr_b32 s63, s43, 2
  buffer_load_dwordx4 v2, s[12:15], s60 offen offset:3072 sc1 lds
  ds_read_b64_tr_b16 v[200:201], v31 offset:36864
  ds_read_b64_tr_b16 v[202:203], v31 offset:37888
  ds_read_b64_tr_b16 v[204:205], v31 offset:36872
  ds_read_b64_tr_b16 v[206:207], v31 offset:37896
  v_mov_b32 v60, 0
  buffer_atomic_add v60, v33, s[12:15], s54 offen sc0 sc1
  s_lshl2_add_u32 s66, s47, s63
  s_add_u32 s66, s66, 768
  s_lshl_b32 s66, s66, 7
  s_lshl2_add_u32 s67, s44, s36
  s_mul_i32 s68, s44, 224
  s_lshl3_add_u32 s72, s67, s45
  s_add_u32 m0, s51, 4096
  s_add_u32 s60, s50, 4096
  buffer_load_dwordx4 v2, s[12:15], s60 offen offset:0 sc1 lds
  ds_read_b64_tr_b16 v[208:209], v31 offset:40960
  ds_read_b64_tr_b16 v[210:211], v31 offset:41984
  ds_read_b64_tr_b16 v[212:213], v31 offset:40968
  ds_read_b64_tr_b16 v[214:215], v31 offset:41992
  s_lshl_b32 s73, s67, 14
  s_add_u32 s67, s67, 768
  s_lshl_b32 s67, s67, 7
  v_and_b32 v8, 48, v1
  v_add_u32 v8, 65536, v8
  v_add_u32 v12, 98304, v2
  buffer_load_dwordx4 v2, s[12:15], s60 offen offset:1024 sc1 lds
  ds_read_b64_tr_b16 v[216:217], v31 offset:45056
  ds_read_b64_tr_b16 v[218:219], v31 offset:46080
  ds_read_b64_tr_b16 v[220:221], v31 offset:45064
  ds_read_b64_tr_b16 v[222:223], v31 offset:46088
  v_and_b32 v11, 31, v1
  v_lshlrev_b32 v11, 2, v11
  v_lshl_add_u32 v11, v47, 8, v11
  s_add_u32 s90, s75, 4096
  v_cmp_gt_u32 s[84:85], 2, v1
  v_lshlrev_b32 v26, 8, v1
  buffer_load_dwordx4 v2, s[12:15], s60 offen offset:2048 sc1 lds
  ds_read_b64_tr_b16 v[224:225], v31 offset:49152
  ds_read_b64_tr_b16 v[226:227], v31 offset:50176
  ds_read_b64_tr_b16 v[228:229], v31 offset:49160
  ds_read_b64_tr_b16 v[230:231], v31 offset:50184
  v_mov_b32 v13, 0x100
  v_cndmask_b32 v30, 0, 8, s[84:85]
  v_cndmask_b32 v29, v33, v26, s[84:85]
  v_mov_b32 v14, 0x10000
  s_add_u32 s62, s36, 0
  s_and_b32 s62, s62, 3
  buffer_load_dwordx4 v2, s[12:15], s60 offen offset:3072 sc1 lds
  ds_read_b64_tr_b16 v[232:233], v31 offset:53248
  ds_read_b64_tr_b16 v[234:235], v31 offset:54272
  ds_read_b64_tr_b16 v[236:237], v31 offset:53256
  ds_read_b64_tr_b16 v[238:239], v31 offset:54280
  s_mul_i32 s63, s62, 57344
  v_add_u32 v40, s63, v2
  s_mul_i32 s63, s62, 12288
  s_add_u32 s63, s63, 0
  v_add_u32 v15, s63, v2
  s_add_u32 s62, s36, 1
  s_add_u32 m0, s51, 32768
  s_add_u32 s60, s50, 32768
  buffer_load_dwordx4 v2, s[12:15], s60 offen offset:0 sc1 lds
  ds_read_b64_tr_b16 v[240:241], v31 offset:57344
  ds_read_b64_tr_b16 v[242:243], v31 offset:58368
  ds_read_b64_tr_b16 v[244:245], v31 offset:57352
  ds_read_b64_tr_b16 v[246:247], v31 offset:58376
  s_and_b32 s62, s62, 3
  s_mul_i32 s63, s62, 57344
  v_add_u32 v41, s63, v2
  s_mul_i32 s63, s62, 12288
  s_add_u32 s63, s63, 0
  v_add_u32 v44, s63, v2
  buffer_load_dwordx4 v2, s[12:15], s60 offen offset:1024 sc1 lds
  ds_read_b64_tr_b16 v[248:249], v31 offset:61440
  ds_read_b64_tr_b16 v[250:251], v31 offset:62464
  ds_read_b64_tr_b16 v[252:253], v31 offset:61448
  ds_read_b64_tr_b16 v[254:255], v31 offset:62472
  s_add_u32 s62, s36, 2
  s_and_b32 s62, s62, 3
  s_mul_i32 s63, s62, 57344
  v_add_u32 v42, s63, v2
  s_mul_i32 s63, s62, 12288
  s_add_u32 s63, s63, 0
  s_waitcnt vmcnt(11) lgkmcnt(0)
  s_barrier
  buffer_load_dwordx4 v2, s[12:15], s60 offen offset:2048 sc1 lds
  buffer_load_dwordx4 v2, s[12:15], s60 offen offset:3072 sc1 lds
  s_waitcnt vmcnt(8)
  v_readfirstlane_b32 s99, v60
  s_nop 0
  s_cmp_lt_u32 s99, 8
  s_cbranch_scc1 L_spin5
L_back5:
  s_add_u32 m0, s86, 131072
  s_add_u32 s60, s55, 0
  buffer_load_dwordx4 v2, s[12:15], s60 offen offset:0 sc1 lds
  buffer_load_dwordx4 v2, s[12:15], s60 offen offset:1024 sc1 lds
  ds_read_b128 v[64:67], v120 offset:0
  ds_read_b128 v[68:71], v120 offset:1024
  ds_read_b128 v[72:75], v120 offset:4096
  ds_read_b128 v[76:79], v120 offset:5120
  s_waitcnt lgkmcnt(3)
  v_mfma_f32_16x16x32_bf16 v[96:99], v[128:131], v[64:67], v[96:99]
  s_add_u32 m0, s86, 147456
  ds_read_b128 v[80:83], v120 offset:8192
  v_add_u32 v45, s63, v2
  s_waitcnt lgkmcnt(3)
  v_mfma_f32_16x16x32_bf16 v[96:99], v[136:139], v[68:71], v[96:99]
  s_add_u32 s60, s55, 16384
  s_add_u32 s62, s36, 3
  s_and_b32 s62, s62, 3
  v_mfma_f32_16x16x32_bf16 v[100:103], v[132:135], v[64:67], v[100:103]
  s_mul_i32 s63, s62, 57344
  ds_read_b128 v[84:87], v120 offset:9216
  v_add_u32 v43, s63, v2
  v_mfma_f32_16x16x32_bf16 v[100:103], v[140:143], v[68:71], v[100:103]
  s_waitcnt lgkmcnt(2)
  buffer_load_dwordx4 v2, s[12:15], s60 offen offset:0 sc1 lds
  s_mul_i32 s63, s62, 12288
  v_mfma_f32_16x16x32_bf16 v[96:99], v[160:163], v[72:75], v[96:99]
  s_add_u32 s63, s63, 0
  ds_read_b128 v[88:91], v120 offset:12288
  v_add_u32 v3, s63, v2
  v_mfma_f32_16x16x32_bf16 v[96:99], v[168:171], v[76:79], v[96:99]
  s_mul_i32 s63, s36, 14
  s_add_u32 s68, s68, s63
  s_lshl_b32 s68, s68, 10
  v_mfma_f32_16x16x32_bf16 v[100:103], v[164:167], v[72:75], v[100:103]
  s_add_u32 s68, s68, 9437184
  ds_read_b128 v[92:95], v120 offset:13312
  buffer_load_dwordx4 v2, s[12:15], s60 offen offset:1024 sc1 lds
  v_mfma_f32_16x16x32_bf16 v[100:103], v[172:175], v[76:79], v[100:103]
  s_waitcnt lgkmcnt(2)
  s_add_u32 s69, s68, 4096
  s_add_u32 s70, s68, 7168
  v_mfma_f32_16x16x32_bf16 v[96:99], v[192:195], v[80:83], v[96:99]
  s_add_u32 m0, s86, 131072
  ds_read_b128 v[64:67], v120 offset:2048
  s_add_u32 s71, s70, 4096
  v_mfma_f32_16x16x32_bf16 v[96:99], v[200:203], v[84:87], v[96:99]
  s_add_u32 s60, s55, 0
  s_lshl_b32 s72, s72, 11
  s_add_u32 s72, s72, 7340032
  v_mfma_f32_16x16x32_bf16 v[100:103], v[196:199], v[80:83], v[100:103]
  s_lshl_b32 s62, s45, 7
  ds_read_b128 v[68:71], v120 offset:3072
  buffer_load_dwordx4 v2, s[12:15], s60 offen offset:2048 sc1 lds
  v_mfma_f32_16x16x32_bf16 v[100:103], v[204:207], v[84:87], v[100:103]
  s_waitcnt lgkmcnt(2)
  s_add_u32 s73, s73, s62
  v_mfma_f32_16x16x32_bf16 v[96:99], v[224:227], v[88:91], v[96:99]
  ds_read_b128 v[72:75], v120 offset:6144
  v_mfma_f32_16x16x32_bf16 v[96:99], v[232:235], v[92:95], v[96:99]
  buffer_load_dwordx4 v2, s[12:15], s60 offen offset:3072 sc1 lds
  v_mfma_f32_16x16x32_bf16 v[100:103], v[228:231], v[88:91], v[100:103]
  s_add_u32 m0, s86, 147456
  ds_read_b128 v[76:79], v120 offset:7168
  v_mfma_f32_16x16x32_bf16 v[100:103], v[236:239], v[92:95], v[100:103]
  s_waitcnt lgkmcnt(2)
  v_mfma_f32_16x16x32_bf16 v[96:99], v[144:147], v[64:67], v[96:99]
  s_add_u32 s60, s55, 16384
  ds_read_b128 v[80:83], v120 offset:10240
  buffer_load_dwordx4 v2, s[12:15], s60 offen offset:2048 sc1 lds
  v_mfma_f32_16x16x32_bf16 v[96:99], v[152:155], v[68:71], v[96:99]
  v_mfma_f32_16x16x32_bf16 v[100:103], v[148:151], v[64:67], v[100:103]
  ds_read_b128 v[84:87], v120 offset:11264
  v_mfma_f32_16x16x32_bf16 v[100:103], v[156:159], v[68:71], v[100:103]
  s_waitcnt lgkmcnt(2)
  v_mfma_f32_16x16x32_bf16 v[96:99], v[176:179], v[72:75], v[96:99]
  ds_read_b128 v[88:91], v120 offset:14336
  buffer_load_dwordx4 v2, s[12:15], s60 offen offset:3072 sc1 lds
  v_mfma_f32_16x16x32_bf16 v[96:99], v[184:187], v[76:79], v[96:99]
  s_add_u32 m0, s51, 36864
  v_mfma_f32_16x16x32_bf16 v[100:103], v[180:183], v[72:75], v[100:103]
  s_add_u32 s60, s50, 36864
  ds_read_b128 v[92:95], v120 offset:15360
  v_mfma_f32_16x16x32_bf16 v[100:103], v[188:191], v[76:79], v[100:103]
  s_waitcnt lgkmcnt(2)
  buffer_load_dwordx4 v2, s[12:15], s60 offen offset:0 sc1 lds
  v_mfma_f32_16x16x32_bf16 v[96:99], v[208:211], v[80:83], v[96:99]
  v_mfma_f32_16x16x32_bf16 v[96:99], v[216:219], v[84:87], v[96:99]
  v_mfma_f32_16x16x32_bf16 v[100:103], v[212:215], v[80:83], v[100:103]
  buffer_load_dwordx4 v2, s[12:15], s60 offen offset:1024 sc1 lds
  v_mfma_f32_16x16x32_bf16 v[100:103], v[220:223], v[84:87], v[100:103]
  s_waitcnt lgkmcnt(0)
  v_mfma_f32_16x16x32_bf16 v[96:99], v[240:243], v[88:91], v[96:99]
  v_mfma_f32_16x16x32_bf16 v[96:99], v[248:251], v[92:95], v[96:99]
  v_mfma_f32_16x16x32_bf16 v[100:103], v[244:247], v[88:91], v[100:103]
  buffer_load_dwordx4 v2, s[12:15], s60 offen offset:2048 sc1 lds
  v_mfma_f32_16x16x32_bf16 v[100:103], v[252:255], v[92:95], v[100:103]
  s_nop 4
  v_cvt_pk_bf16_f32 v112, v96, v97
  v_cvt_pk_bf16_f32 v113, v98, v99
  s_nop 0
  v_cvt_pk_bf16_f32 v114, v100, v101
  v_cvt_pk_bf16_f32 v115, v102, v103
  buffer_store_dwordx4 v[112:115], v2, s[12:15], s80 offen sc1
  v_pk_add_f32 v[56:57], v[96:97], v[98:99]
  v_pk_mul_f32 v[58:59], v[96:97], v[96:97]
  v_pk_fma_f32 v[58:59], v[98:99], v[98:99], v[58:59]
  v_pk_add_f32 v[56:57], v[56:57], v[100:101]
  v_pk_fma_f32 v[58:59], v[100:101], v[100:101], v[58:59]
  v_pk_add_f32 v[56:57], v[56:57], v[102:103]
  v_pk_fma_f32 v[58:59], v[102:103], v[102:103], v[58:59]
  v_add_f32 v56, v56, v57
  v_add_f32 v58, v58, v59
  s_nop 1
  v_permlane32_swap_b32 v56, v58
  v_add_f32 v56, v56, v58
  v_mov_b32 v58, v56
  s_nop 1
  v_permlane16_swap_b32 v56, v58
  v_add_f32 v56, v56, v58
  buffer_store_dword v56, v123, s[12:15], s82 offen sc1
  s_waitcnt vmcnt(9)
  s_barrier
  ds_read_b128 v[64:67], v124 offset:0
  ds_read_b128 v[68:71], v124 offset:1024
  ds_read_b128 v[72:75], v124 offset:4096
  ds_read_b128 v[76:79], v124 offset:5120
  s_waitcnt lgkmcnt(3)
  v_mfma_f32_16x16x32_bf16 v[104:107], v[128:131], v[64:67], v[104:107]
  ds_read_b128 v[80:83], v124 offset:8192
  s_waitcnt lgkmcnt(3)
  v_mfma_f32_16x16x32_bf16 v[104:107], v[136:139], v[68:71], v[104:107]
  v_mfma_f32_16x16x32_bf16 v[108:111], v[132:135], v[64:67], v[108:111]
  ds_read_b128 v[84:87], v124 offset:9216
  v_mfma_f32_16x16x32_bf16 v[108:111], v[140:143], v[68:71], v[108:111]
  s_waitcnt lgkmcnt(2)
  buffer_load_dwordx4 v2, s[12:15], s60 offen offset:3072 sc1 lds
  v_mfma_f32_16x16x32_bf16 v[104:107], v[160:163], v[72:75], v[104:107]
  s_add_u32 m0, s51, 98304
  ds_read_b128 v[88:91], v124 offset:12288
  v_mfma_f32_16x16x32_bf16 v[104:107], v[168:171], v[76:79], v[104:107]
  s_add_u32 s60, s50, 65536
  v_mfma_f32_16x16x32_bf16 v[108:111], v[164:167], v[72:75], v[108:111]
  ds_read_b128 v[92:95], v124 offset:13312
  buffer_load_dwordx4 v2, s[12:15], s60 offen offset:0 sc1 lds
  v_mfma_f32_16x16x32_bf16 v[108:111], v[172:175], v[76:79], v[108:111]
  s_waitcnt lgkmcnt(2)
  v_mfma_f32_16x16x32_bf16 v[104:107], v[192:195], v[80:83], v[104:107]
  s_waitcnt vmcnt(7)
  s_barrier
  ds_read_b128 v[64:67], v124 offset:2048
  v_mfma_f32_16x16x32_bf16 v[104:107], v[200:203], v[84:87], v[104:107]
  buffer_load_dwordx4 v2, s[12:15], s60 offen offset:1024 sc1 lds
  v_mfma_f32_16x16x32_bf16 v[108:111], v[196:199], v[80:83], v[108:111]
  ds_read_b128 v[68:71], v124 offset:3072
  v_mfma_f32_16x16x32_bf16 v[108:111], v[204:207], v[84:87], v[108:111]
  s_waitcnt lgkmcnt(2)
  v_mfma_f32_16x16x32_bf16 v[104:107], v[224:227], v[88:91], v[104:107]
  ds_read_b128 v[72:75], v124 offset:6144
  buffer_load_dwordx4 v2, s[12:15], s60 offen offset:2048 sc1 lds
  v_mfma_f32_16x16x32_bf16 v[104:107], v[232:235], v[92:95], v[104:107]
  v_mfma_f32_16x16x32_bf16 v[108:111], v[228:231], v[88:91], v[108:111]
  ds_read_b128 v[76:79], v124 offset:7168
  v_mfma_f32_16x16x32_bf16 v[108:111], v[236:239], v[92:95], v[108:111]
  s_waitcnt lgkmcnt(2)
  buffer_load_dwordx4 v2, s[12:15], s60 offen offset:3072 sc1 lds
  v_mfma_f32_16x16x32_bf16 v[104:107], v[144:147], v[64:67], v[104:107]
  s_add_u32 m0, s51, 102400
  ds_read_b128 v[80:83], v124 offset:10240
  s_waitcnt vmcnt(5)
  buffer_atomic_add v34, v33, s[12:15], s58 offen offset:512 sc1
  v_mfma_f32_16x16x32_bf16 v[104:107], v[152:155], v[68:71], v[104:107]
  s_add_u32 s60, s50, 69632
  v_mfma_f32_16x16x32_bf16 v[108:111], v[148:151], v[64:67], v[108:111]
  ds_read_b128 v[84:87], v124 offset:11264
  v_mfma_f32_16x16x32_bf16 v[108:111], v[156:159], v[68:71], v[108:111]
  s_waitcnt lgkmcnt(2)
  buffer_load_dwordx4 v2, s[12:15], s60 offen offset:0 sc1 lds
  v_mfma_f32_16x16x32_bf16 v[104:107], v[176:179], v[72:75], v[104:107]
  ds_read_b128 v[88:91], v124 offset:14336
  v_mfma_f32_16x16x32_bf16 v[104:107], v[184:187], v[76:79], v[104:107]
  v_mfma_f32_16x16x32_bf16 v[108:111], v[180:183], v[72:75], v[108:111]
  ds_read_b128 v[92:95], v124 offset:15360
  buffer_load_dwordx4 v2, s[12:15], s60 offen offset:1024 sc1 lds
  v_mfma_f32_16x16x32_bf16 v[108:111], v[188:191], v[76:79], v[108:111]
  s_waitcnt lgkmcnt(2)
  v_mfma_f32_16x16x32_bf16 v[104:107], v[208:211], v[80:83], v[104:107]
  v_mfma_f32_16x16x32_bf16 v[104:107], v[216:219], v[84:87], v[104:107]
  buffer_load_dwordx4 v2, s[12:15], s60 offen offset:2048 sc1 lds
  v_mfma_f32_16x16x32_bf16 v[108:111], v[212:215], v[80:83], v[108:111]
  v_mfma_f32_16x16x32_bf16 v[108:111], v[220:223], v[84:87], v[108:111]
  s_waitcnt lgkmcnt(0)
  v_mfma_f32_16x16x32_bf16 v[104:107], v[240:243], v[88:91], v[104:107]
  buffer_load_dwordx4 v2, s[12:15], s60 offen offset:3072 sc1 lds
  v_mfma_f32_16x16x32_bf16 v[104:107], v[248:251], v[92:95], v[104:107]
  s_add_u32 s57, s49, 16384
  v_mfma_f32_16x16x32_bf16 v[108:111], v[244:247], v[88:91], v[108:111]
  v_mfma_f32_16x16x32_bf16 v[108:111], v[252:255], v[92:95], v[108:111]
  buffer_load_dwordx4 a[72:75], v2, s[12:15], s57 offen offset:2048 sc1
  s_nop 3
  v_cvt_pk_bf16_f32 v116, v104, v105
  v_cvt_pk_bf16_f32 v117, v106, v107
  s_nop 0
  v_cvt_pk_bf16_f32 v118, v108, v109
  v_cvt_pk_bf16_f32 v119, v110, v111
  buffer_store_dwordx4 v[116:119], v2, s[12:15], s81 offen sc1
  v_pk_add_f32 v[56:57], v[104:105], v[106:107]
  v_pk_mul_f32 v[58:59], v[104:105], v[104:105]
  v_pk_fma_f32 v[58:59], v[106:107], v[106:107], v[58:59]
  v_pk_add_f32 v[56:57], v[56:57], v[108:109]
  v_pk_fma_f32 v[58:59], v[108:109], v[108:109], v[58:59]
  v_pk_add_f32 v[56:57], v[56:57], v[110:111]
  v_pk_fma_f32 v[58:59], v[110:111], v[110:111], v[58:59]
  v_add_f32 v56, v56, v57
  v_add_f32 v58, v58, v59
  s_nop 1
  v_permlane32_swap_b32 v56, v58
  v_add_f32 v56, v56, v58
  v_mov_b32 v58, v56
  s_nop 1
  v_permlane16_swap_b32 v56, v58
  v_add_f32 v56, v56, v58
  buffer_store_dword v56, v123, s[12:15], s83 offen sc1
  v_min_u32 v121, 223, v0
  v_lshrrev_b32 v24, 5, v121
  v_and_b32 v25, 31, v121
  v_lshlrev_b32 v25, 2, v25
  v_lshl_add_u32 v24, v24, 10, v25
  s_mul_i32 s62, s43, 7168
  s_add_u32 s62, s62, 24117248
  buffer_load_dword v48, v24, s[12:15], s62 offen offset:0 sc1
  buffer_load_dword v49, v24, s[12:15], s62 offen offset:128 sc1
  buffer_load_dword v50, v24, s[12:15], s62 offen offset:256 sc1
  buffer_load_dword v51, v24, s[12:15], s62 offen offset:384 sc1
  buffer_load_dword v52, v24, s[12:15], s62 offen offset:512 sc1
  buffer_load_dword v53, v24, s[12:15], s62 offen offset:640 sc1
  buffer_load_dword v54, v24, s[12:15], s62 offen offset:768 sc1
  buffer_load_dword v55, v24, s[12:15], s62 offen offset:896 sc1
  s_getpc_b64 s[78:79]
L_pcbase2:
  s_lshr_b32 s63, s2, 3
  s_lshl2_add_u32 s62, s63, s36
  s_lshl_b32 s62, s62, 8
  s_min_u32 s62, s62, L_codeend-L_pcbase2-256
  s_add_u32 s78, s78, s62
  s_addc_u32 s79, s79, 0
  s_load_dword s95, s[78:79], 0
  s_load_dword s95, s[78:79], 64
  s_load_dword s95, s[78:79], 128
  s_load_dword s95, s[78:79], 192
  v_mov_b32 v9, 0
  buffer_atomic_add v9, v29, s[12:15], s89 offen sc0 sc1
  s_waitcnt vmcnt(9)
  buffer_atomic_add v34, v33, s[12:15], s58 offen offset:0 sc1
  v_lshlrev_b32 v121, 2, v121
  v_add_u32 v121, 65536, v121
  s_waitcnt vmcnt(2)
  v_add_f32 v122, v55, v54
  v_add_f32 v122, v122, v48
  v_add_f32 v122, v122, v49
  v_add_f32 v122, v122, v50
  v_add_f32 v122, v122, v51
  v_add_f32 v122, v122, v52
  v_add_f32 v122, v122, v53
  ds_write_b32 v121, v122
  s_waitcnt vmcnt(1)
  v_cmp_gt_u32 vcc, v30, v9
  s_nop 0
  s_cmp_lg_u32 vcc_lo, 0
  s_cbranch_scc1 L_spin6
L_back6:
  s_add_u32 s74, s77, 32768
  buffer_load_dwordx4 v[128:131], v2, s[12:15], s74 offen offset:0 sc1
  buffer_load_dwordx4 v[136:139], v2, s[12:15], s74 offen offset:1024 sc1
  buffer_load_dwordx4 v[144:147], v2, s[12:15], s74 offen offset:2048 sc1
  buffer_load_dwordx4 v[152:155], v2, s[12:15], s74 offen offset:3072 sc1
  s_add_u32 s74, s77, 36864
  buffer_load_dwordx4 v[160:163], v2, s[12:15], s74 offen offset:0 sc1
  buffer_load_dwordx4 v[168:171], v2, s[12:15], s74 offen offset:1024 sc1
  buffer_load_dwordx4 v[176:179], v2, s[12:15], s74 offen offset:2048 sc1
  buffer_load_dwordx4 v[184:187], v2, s[12:15], s74 offen offset:3072 sc1
  s_add_u32 s74, s77, 40960
  buffer_load_dwordx4 v[192:195], v2, s[12:15], s74 offen offset:0 sc1
  buffer_load_dwordx4 v[200:203], v2, s[12:15], s74 offen offset:1024 sc1
  s_waitcnt lgkmcnt(0)
  s_barrier
  ds_read_b128 a[224:227], v2 offset:0
  ds_read_b128 a[228:231], v2 offset:2048
  ds_read_b128 a[232:235], v2 offset:1024
  ds_read_b128 a[236:239], v2 offset:3072
  ds_read_b128 a[240:243], v2 offset:32768
  ds_read_b128 a[244:247], v2 offset:34816
  ds_read_b128 a[248:251], v2 offset:33792
  ds_read_b128 a[252:255], v2 offset:35840
  ds_read_b128 v[48:51], v2 offset:4096
  ds_read_b128 v[52:55], v2 offset:6144
  s_waitcnt vmcnt(9) lgkmcnt(9)
  v_mfma_f32_16x16x32_bf16 v[64:67], a[224:227], v[128:131], 0
  ds_read_b128 v[56:59], v2 offset:5120
  s_waitcnt vmcnt(8) lgkmcnt(9)
  v_mfma_f32_16x16x32_bf16 v[64:67], a[228:231], v[136:139], v[64:67]
  s_waitcnt lgkmcnt(7)
  ds_read_b128 v[60:63], v2 offset:7168
  buffer_load_dwordx4 v[208:211], v2, s[12:15], s74 offen offset:2048 sc1
  v_mfma_f32_16x16x32_bf16 v[72:75], a[232:235], v[128:131], 0
  ds_read_b128 a[224:227], v2 offset:36864
  v_mfma_f32_16x16x32_bf16 v[72:75], a[236:239], v[136:139], v[72:75]
  s_waitcnt lgkmcnt(7)
  ds_read_b128 a[228:231], v2 offset:38912
  v_mfma_f32_16x16x32_bf16 v[80:83], a[240:243], v[128:131], 0
  ds_read_b128 a[232:235], v2 offset:37888
  v_mfma_f32_16x16x32_bf16 v[80:83], a[244:247], v[136:139], v[80:83]
  s_waitcnt lgkmcnt(7)
  ds_read_b128 a[236:239], v2 offset:39936
  buffer_load_dwordx4 v[216:219], v2, s[12:15], s74 offen offset:3072 sc1
  v_mfma_f32_16x16x32_bf16 v[88:91], a[248:251], v[128:131], 0
  s_add_u32 s74, s77, 45056
  ds_read_b128 a[240:243], v2 offset:8192
  v_mfma_f32_16x16x32_bf16 v[88:91], a[252:255], v[136:139], v[88:91]
  s_waitcnt vmcnt(8) lgkmcnt(7)
  ds_read_b128 a[244:247], v2 offset:10240
  v_mfma_f32_16x16x32_bf16 v[64:67], v[48:51], v[144:147], v[64:67]
  ds_read_b128 a[248:251], v2 offset:9216
  v_mov_b32 v10, 0
  buffer_atomic_add v10, v29, s[12:15], s76 offen sc0 sc1
  v_mfma_f32_16x16x32_bf16 v[64:67], v[52:55], v[152:155], v[64:67]
  s_waitcnt lgkmcnt(7)
  ds_read_b128 a[252:255], v2 offset:11264
  buffer_load_dwordx4 v[224:227], v2, s[12:15], s74 offen offset:0 sc1
  v_mfma_f32_16x16x32_bf16 v[72:75], v[56:59], v[144:147], v[72:75]
  ds_read_b128 v[48:51], v2 offset:40960
  v_mfma_f32_16x16x32_bf16 v[72:75], v[60:63], v[152:155], v[72:75]
  s_waitcnt lgkmcnt(7)
  ds_read_b128 v[52:55], v2 offset:43008
  v_mfma_f32_16x16x32_bf16 v[80:83], a[224:227], v[144:147], v[80:83]
  ds_read_b128 v[56:59], v2 offset:41984
  buffer_load_dwordx4 v[232:235], v2, s[12:15], s74 offen offset:1024 sc1
  v_mfma_f32_16x16x32_bf16 v[80:83], a[228:231], v[152:155], v[80:83]
  s_waitcnt lgkmcnt(7)
  ds_read_b128 v[60:63], v2 offset:44032
  v_mfma_f32_16x16x32_bf16 v[88:91], a[232:235], v[144:147], v[88:91]
  ds_read_b128 a[224:227], v2 offset:12288
  v_mfma_f32_16x16x32_bf16 v[88:91], a[236:239], v[152:155], v[88:91]
  s_waitcnt vmcnt(9) lgkmcnt(7)
  ds_read_b128 a[228:231], v2 offset:14336
  v_mfma_f32_16x16x32_bf16 v[64:67], a[240:243], v[160:163], v[64:67]
  ds_read_b128 a[232:235], v2 offset:13312
  buffer_load_dwordx4 v[240:243], v2, s[12:15], s74 offen offset:2048 sc1
  v_mfma_f32_16x16x32_bf16 v[64:67], a[244:247], v[168:171], v[64:67]
  s_waitcnt lgkmcnt(7)
  ds_read_b128 a[236:239], v2 offset:15360
  v_mfma_f32_16x16x32_bf16 v[72:75], a[248:251], v[160:163], v[72:75]
  ds_read_b128 a[240:243], v2 offset:45056
  v_mfma_f32_16x16x32_bf16 v[72:75], a[252:255], v[168:171], v[72:75]
  s_waitcnt lgkmcnt(7)
  ds_read_b128 a[244:247], v2 offset:47104
  v_mfma_f32_16x16x32_bf16 v[80:83], v[48:51], v[160:163], v[80:83]
  ds_read_b128 a[248:251], v2 offset:46080
  buffer_load_dwordx4 v[248:251], v2, s[12:15], s74 offen offset:3072 sc1
  v_mfma_f32_16x16x32_bf16 v[80:83], v[52:55], v[168:171], v[80:83]
  s_waitcnt lgkmcnt(7)
  ds_read_b128 a[252:255], v2 offset:48128
  v_mfma_f32_16x16x32_bf16 v[88:91], v[56:59], v[160:163], v[88:91]
  ds_read_b128 v[48:51], v2 offset:16384
  buffer_load_dword v112, v11, s[12:15], s90 offen offset:0 sc1
  v_mfma_f32_16x16x32_bf16 v[88:91], v[60:63], v[168:171], v[88:91]
  s_waitcnt vmcnt(10) lgkmcnt(7)
  ds_read_b128 v[52:55], v2 offset:18432
  v_mfma_f32_16x16x32_bf16 v[64:67], a[224:227], v[176:179], v[64:67]
  ds_read_b128 v[56:59], v2 offset:17408
  buffer_load_dword v113, v11, s[12:15], s90 offen offset:512 sc1
  v_mfma_f32_16x16x32_bf16 v[64:67], a[228:231], v[184:187], v[64:67]
  s_waitcnt lgkmcnt(7)
  ds_read_b128 v[60:63], v2 offset:19456
  v_mfma_f32_16x16x32_bf16 v[72:75], a[232:235], v[176:179], v[72:75]
  ds_read_b128 a[224:227], v2 offset:49152
  buffer_load_dword v114, v11, s[12:15], s90 offen offset:1024 sc1
  v_mfma_f32_16x16x32_bf16 v[72:75], a[236:239], v[184:187], v[72:75]
  s_waitcnt lgkmcnt(7)
  ds_read_b128 a[228:231], v2 offset:51200
  v_mfma_f32_16x16x32_bf16 v[80:83], a[240:243], v[176:179], v[80:83]
  ds_read_b128 a[232:235], v2 offset:50176
  buffer_load_dword v115, v11, s[12:15], s90 offen offset:1536 sc1
  v_mfma_f32_16x16x32_bf16 v[80:83], a[244:247], v[184:187], v[80:83]
  s_waitcnt lgkmcnt(7)
  ds_read_b128 a[236:239], v2 offset:52224
  v_mfma_f32_16x16x32_bf16 v[88:91], a[248:251], v[176:179], v[88:91]
  ds_read_b128 a[240:243], v2 offset:20480
  buffer_load_dword v116, v11, s[12:15], s90 offen offset:2048 sc1
  v_mfma_f32_16x16x32_bf16 v[88:91], a[252:255], v[184:187], v[88:91]
  s_waitcnt vmcnt(12) lgkmcnt(7)
  ds_read_b128 a[244:247], v2 offset:22528
  v_mfma_f32_16x16x32_bf16 v[64:67], v[48:51], v[192:195], v[64:67]
  ds_read_b128 a[248:251], v2 offset:21504
  buffer_load_dword v117, v11, s[12:15], s90 offen offset:2560 sc1
  v_mfma_f32_16x16x32_bf16 v[64:67], v[52:55], v[200:203], v[64:67]
  s_waitcnt lgkmcnt(7)
  ds_read_b128 a[252:255], v2 offset:23552
  v_mfma_f32_16x16x32_bf16 v[72:75], v[56:59], v[192:195], v[72:75]
  ds_read_b128 v[48:51], v2 offset:53248
  buffer_load_dword v118, v11, s[12:15], s90 offen offset:3072 sc1
  v_mfma_f32_16x16x32_bf16 v[72:75], v[60:63], v[200:203], v[72:75]
  s_waitcnt lgkmcnt(7)
  ds_read_b128 v[52:55], v2 offset:55296
  buffer_load_dword v119, v11, s[12:15], s90 offen offset:3584 sc1
  s_waitcnt vmcnt(12)
  v_cmp_gt_u32 vcc, v30, v10
  s_nop 0
  s_cmp_lg_u32 vcc_lo, 0
  s_cbranch_scc1 L_spin7
L_back7:
  s_add_u32 s74, s77, 0
  buffer_load_dwordx4 v[132:135], v2, s[12:15], s74 offen offset:0 sc1
  buffer_load_dwordx4 v[140:143], v2, s[12:15], s74 offen offset:1024 sc1
  buffer_load_dwordx4 v[148:151], v2, s[12:15], s74 offen offset:2048 sc1
  buffer_load_dwordx4 v[156:159], v2, s[12:15], s74 offen offset:3072 sc1
  s_add_u32 s74, s77, 4096
  buffer_load_dwordx4 v[164:167], v2, s[12:15], s74 offen offset:0 sc1
  buffer_load_dwordx4 v[172:175], v2, s[12:15], s74 offen offset:1024 sc1
  v_mfma_f32_16x16x32_bf16 v[80:83], a[224:227], v[192:195], v[80:83]
  ds_read_b128 v[56:59], v2 offset:54272
  v_mfma_f32_16x16x32_bf16 v[80:83], a[228:231], v[200:203], v[80:83]
  s_waitcnt lgkmcnt(7)
  ds_read_b128 v[60:63], v2 offset:56320
  buffer_load_dwordx4 v[180:183], v2, s[12:15], s74 offen offset:2048 sc1
  v_mfma_f32_16x16x32_bf16 v[88:91], a[232:235], v[192:195], v[88:91]
  ds_read_b128 a[224:227], v2 offset:24576
  v_mfma_f32_16x16x32_bf16 v[88:91], a[236:239], v[200:203], v[88:91]
  s_waitcnt lgkmcnt(7)
  ds_read_b128 a[228:231], v2 offset:26624
  v_mfma_f32_16x16x32_bf16 v[64:67], a[240:243], v[208:211], v[64:67]
  ds_read_b128 a[232:235], v2 offset:25600
  buffer_load_dwordx4 v[188:191], v2, s[12:15], s74 offen offset:3072 sc1
  v_mfma_f32_16x16x32_bf16 v[64:67], a[244:247], v[216:219], v[64:67]
  s_waitcnt lgkmcnt(7)
  ds_read_b128 a[236:239], v2 offset:27648
  v_mfma_f32_16x16x32_bf16 v[72:75], a[248:251], v[208:211], v[72:75]
  s_add_u32 s74, s77, 8192
  ds_read_b128 a[240:243], v2 offset:57344
  v_mfma_f32_16x16x32_bf16 v[72:75], a[252:255], v[216:219], v[72:75]
  s_waitcnt lgkmcnt(7)
  ds_read_b128 a[244:247], v2 offset:59392
  v_mfma_f32_16x16x32_bf16 v[80:83], v[48:51], v[208:211], v[80:83]
  ds_read_b128 a[248:251], v2 offset:58368
  buffer_load_dwordx4 v[196:199], v2, s[12:15], s74 offen offset:0 sc1
  v_mfma_f32_16x16x32_bf16 v[80:83], v[52:55], v[216:219], v[80:83]
  s_waitcnt lgkmcnt(7)
  ds_read_b128 a[252:255], v2 offset:60416
  v_mfma_f32_16x16x32_bf16 v[88:91], v[56:59], v[208:211], v[88:91]
  ds_read_b128 v[48:51], v2 offset:28672
  v_mfma_f32_16x16x32_bf16 v[88:91], v[60:63], v[216:219], v[88:91]
  s_waitcnt vmcnt(19) lgkmcnt(7)
  ds_read_b128 v[52:55], v2 offset:30720
  v_mfma_f32_16x16x32_bf16 v[64:67], a[224:227], v[224:227], v[64:67]
  ds_read_b128 v[56:59], v2 offset:29696
  buffer_load_dwordx4 v[204:207], v2, s[12:15], s74 offen offset:1024 sc1
  v_mfma_f32_16x16x32_bf16 v[64:67], a[228:231], v[232:235], v[64:67]
  s_waitcnt lgkmcnt(7)
  ds_read_b128 v[60:63], v2 offset:31744
  v_mfma_f32_16x16x32_bf16 v[72:75], a[232:235], v[224:227], v[72:75]
  ds_read_b128 a[224:227], v2 offset:61440
  v_mfma_f32_16x16x32_bf16 v[72:75], a[236:239], v[232:235], v[72:75]
  s_waitcnt lgkmcnt(7)
  ds_read_b128 a[228:231], v2 offset:63488
  v_mfma_f32_16x16x32_bf16 v[80:83], a[240:243], v[224:227], v[80:83]
  ds_read_b128 a[232:235], v2 offset:62464
  buffer_load_dwordx4 v[212:215], v2, s[12:15], s74 offen offset:2048 sc1
  v_mfma_f32_16x16x32_bf16 v[80:83], a[244:247], v[232:235], v[80:83]
  s_waitcnt lgkmcnt(7)
  ds_read_b128 a[236:239], v2 offset:64512
  v_mfma_f32_16x16x32_bf16 v[88:91], a[248:251], v[224:227], v[88:91]
  ds_read_b128 a[240:243], v2 offset:0
  v_mfma_f32_16x16x32_bf16 v[88:91], a[252:255], v[232:235], v[88:91]
  s_waitcnt vmcnt(19) lgkmcnt(7)
  ds_read_b128 a[244:247], v2 offset:2048
  buffer_load_dwordx4 v[220:223], v2, s[12:15], s74 offen offset:3072 sc1
  v_mfma_f32_16x16x32_bf16 v[64:67], v[48:51], v[240:243], v[64:67]
  s_add_u32 s74, s77, 12288
  ds_read_b128 a[248:251], v2 offset:1024
  ds_read_b128 v[16:19], v8 offset:0
  ds_read_b128 v[20:23], v8 offset:64
  v_mfma_f32_16x16x32_bf16 v[64:67], v[52:55], v[248:251], v[64:67]
  s_waitcnt lgkmcnt(9)
  ds_read_b128 a[252:255], v2 offset:3072
  s_waitcnt vmcnt(12)
  v_add_f32 v112, v112, v119
  v_add_f32 v112, v112, v118
  v_mfma_f32_16x16x32_bf16 v[72:75], v[56:59], v[240:243], v[72:75]
  ds_read_b128 v[48:51], v2 offset:32768
  v_add_f32 v112, v112, v117
  v_add_f32 v112, v112, v116
  v_mfma_f32_16x16x32_bf16 v[72:75], v[60:63], v[248:251], v[72:75]
  s_waitcnt lgkmcnt(9)
  ds_read_b128 v[52:55], v2 offset:34816
  buffer_load_dwordx4 v[228:231], v2, s[12:15], s74 offen offset:0 sc1
  v_mfma_f32_16x16x32_bf16 v[80:83], a[224:227], v[240:243], v[80:83]
  ds_read_b128 v[56:59], v2 offset:33792
  v_add_f32 v112, v112, v115
  v_add_f32 v112, v112, v114
  v_mfma_f32_16x16x32_bf16 v[80:83], a[228:231], v[248:251], v[80:83]
  s_waitcnt lgkmcnt(9)
  ds_read_b128 v[60:63], v2 offset:35840
  v_add_f32 v112, v112, v113
  v_mov_b32 v113, v112
  v_mfma_f32_16x16x32_bf16 v[88:91], a[232:235], v[240:243], v[88:91]
  ds_read_b128 a[224:227], v2 offset:4096
  v_mov_b32 v115, 0x3b000000
  v_permlane32_swap_b32 v112, v113
  v_mfma_f32_16x16x32_bf16 v[88:91], a[236:239], v[248:251], v[88:91]
  s_waitcnt vmcnt(11) lgkmcnt(9)
  ds_read_b128 a[228:231], v2 offset:6144
  buffer_load_dwordx4 v[236:239], v2, s[12:15], s74 offen offset:1024 sc1
  v_mfma_f32_16x16x32_bf16 v[68:71], a[240:243], v[132:135], 0
  ds_read_b128 a[232:235], v2 offset:5120
  v_add_f32 v112, v112, v113
  v_mov_b32 v113, v112
  v_mfma_f32_16x16x32_bf16 v[68:71], a[244:247], v[140:143], v[68:71]
  s_waitcnt lgkmcnt(7)
  ds_read_b128 a[236:239], v2 offset:7168
  v_permlane16_swap_b32 v112, v113
  v_mul_f32 v4, 0xbb000000, v112
  v_mfma_f32_16x16x32_bf16 v[76:79], a[248:251], v[132:135], 0
  ds_read_b128 a[240:243], v2 offset:36864
  buffer_load_dwordx4 v[244:247], v2, s[12:15], s74 offen offset:2048 sc1
  v_mfma_f32_16x16x32_bf16 v[76:79], a[252:255], v[140:143], v[76:79]
  s_waitcnt lgkmcnt(7)
  ds_read_b128 a[244:247], v2 offset:38912
  v_mul_f32 v114, v4, v4
  v_fma_f32 v113, v113, v115, -v114
  v_mfma_f32_16x16x32_bf16 v[84:87], v[48:51], v[132:135], 0
  ds_read_b128 a[248:251], v2 offset:37888
  v_max_f32 v113, 0, v113
  v_add_f32 v113, 0x3727c5ac, v113
  v_mfma_f32_16x16x32_bf16 v[84:87], v[52:55], v[140:143], v[84:87]
  s_waitcnt lgkmcnt(7)
  ds_read_b128 a[252:255], v2 offset:39936
  v_rsq_f32 v5, v113
  v_mfma_f32_16x16x32_bf16 v[92:95], v[56:59], v[132:135], 0
  ds_read_b128 v[48:51], v2 offset:8192
  buffer_load_dwordx4 v[252:255], v2, s[12:15], s74 offen offset:3072 sc1
  v_mfma_f32_16x16x32_bf16 v[92:95], v[60:63], v[140:143], v[92:95]
  s_waitcnt vmcnt(12) lgkmcnt(7)
  ds_read_b128 v[52:55], v2 offset:10240
  v_sqrt_f32 v6, v113
  v_mfma_f32_16x16x32_bf16 v[68:71], a[224:227], v[148:151], v[68:71]
  ds_read_b128 v[56:59], v2 offset:9216
  buffer_load_dword v120, v11, s[12:15], s75 offen offset:0 sc1
  v_mfma_f32_16x16x32_bf16 v[68:71], a[228:231], v[156:159], v[68:71]
  s_waitcnt lgkmcnt(7)
  ds_read_b128 v[60:63], v2 offset:11264
  v_mul_f32 v5, 0xbfb8aa3b, v5
  v_fmac_f32 v64, v16, v4
  v_mfma_f32_16x16x32_bf16 v[76:79], a[232:235], v[148:151], v[76:79]
  ds_read_b128 a[224:227], v2 offset:40960
  buffer_load_dword v121, v11, s[12:15], s75 offen offset:512 sc1
  v_mfma_f32_16x16x32_bf16 v[76:79], a[236:239], v[156:159], v[76:79]
  s_waitcnt lgkmcnt(7)
  ds_read_b128 a[228:231], v2 offset:43008
  v_fmac_f32 v65, v17, v4
  v_fmac_f32 v66, v18, v4
  v_mfma_f32_16x16x32_bf16 v[84:87], a[240:243], v[148:151], v[84:87]
  ds_read_b128 a[232:235], v2 offset:41984
  buffer_load_dword v122, v11, s[12:15], s75 offen offset:1024 sc1
  v_mfma_f32_16x16x32_bf16 v[84:87], a[244:247], v[156:159], v[84:87]
  s_waitcnt lgkmcnt(7)
  ds_read_b128 a[236:239], v2 offset:44032
  v_fmac_f32 v67, v19, v4
  v_mul_f32 v64, v64, v5
  v_mfma_f32_16x16x32_bf16 v[92:95], a[248:251], v[148:151], v[92:95]
  ds_read_b128 a[240:243], v2 offset:12288
  ds_read_b128 v[16:19], v8 offset:128
  buffer_load_dword v123, v11, s[12:15], s75 offen offset:1536 sc1
  v_mfma_f32_16x16x32_bf16 v[92:95], a[252:255], v[156:159], v[92:95]
  s_waitcnt vmcnt(14) lgkmcnt(8)
  ds_read_b128 a[244:247], v2 offset:14336
  v_exp_f32 v64, v64
  v_mfma_f32_16x16x32_bf16 v[68:71], v[48:51], v[164:167], v[68:71]
  ds_read_b128 a[248:251], v2 offset:13312
  buffer_load_dword v124, v11, s[12:15], s75 offen offset:2048 sc1
  v_mfma_f32_16x16x32_bf16 v[68:71], v[52:55], v[172:175], v[68:71]
  s_waitcnt lgkmcnt(8)
  ds_read_b128 a[252:255], v2 offset:15360
  v_mul_f32 v65, v65, v5
  v_mul_f32 v66, v66, v5
  v_mfma_f32_16x16x32_bf16 v[76:79], v[56:59], v[164:167], v[76:79]
  ds_read_b128 v[48:51], v2 offset:45056
  buffer_load_dword v125, v11, s[12:15], s75 offen offset:2560 sc1
  v_mfma_f32_16x16x32_bf16 v[76:79], v[60:63], v[172:175], v[76:79]
  s_waitcnt lgkmcnt(8)
  ds_read_b128 v[52:55], v2 offset:47104
  v_exp_f32 v65, v65
  v_mfma_f32_16x16x32_bf16 v[84:87], a[224:227], v[164:167], v[84:87]
  ds_read_b128 v[56:59], v2 offset:46080
  buffer_load_dword v126, v11, s[12:15], s75 offen offset:3072 sc1
  v_mfma_f32_16x16x32_bf16 v[84:87], a[228:231], v[172:175], v[84:87]
  s_waitcnt lgkmcnt(8)
  ds_read_b128 v[60:63], v2 offset:48128
  v_exp_f32 v66, v66
  v_mfma_f32_16x16x32_bf16 v[92:95], a[232:235], v[164:167], v[92:95]
  ds_read_b128 a[224:227], v2 offset:16384
  buffer_load_dword v127, v11, s[12:15], s75 offen offset:3584 sc1
  v_mfma_f32_16x16x32_bf16 v[92:95], a[236:239], v[172:175], v[92:95]
  s_waitcnt vmcnt(16) lgkmcnt(7)
  ds_read_b128 a[228:231], v2 offset:18432
  v_mul_f32 v67, v67, v5
  v_fmac_f32 v72, v20, v4
  v_mfma_f32_16x16x32_bf16 v[68:71], a[240:243], v[180:183], v[68:71]
  s_add_u32 m0, s51, 131072
  ds_read_b128 a[232:235], v2 offset:17408
  v_exp_f32 v67, v67
  v_mfma_f32_16x16x32_bf16 v[68:71], a[244:247], v[188:191], v[68:71]
  s_waitcnt lgkmcnt(7)
  ds_read_b128 a[236:239], v2 offset:19456
  v_fmac_f32 v73, v21, v4
  v_fmac_f32 v74, v22, v4
  v_mfma_f32_16x16x32_bf16 v[76:79], a[248:251], v[180:183], v[76:79]
  s_add_u32 s60, s50, 98304
  ds_read_b128 a[240:243], v2 offset:49152
  v_fmac_f32 v75, v23, v4
  v_fma_f32 v64, v64, v6, v6
  v_mfma_f32_16x16x32_bf16 v[76:79], a[252:255], v[188:191], v[76:79]
  s_waitcnt lgkmcnt(7)
  ds_read_b128 a[244:247], v2 offset:51200
  ds_read_b128 v[20:23], v8 offset:192
  buffer_load_dwordx4 v2, s[12:15], s60 offen offset:0 sc1 lds
  v_mfma_f32_16x16x32_bf16 v[84:87], v[48:51], v[180:183], v[84:87]
  ds_read_b128 a[248:251], v2 offset:50176
  v_rcp_f32 v64, v64
  v_mfma_f32_16x16x32_bf16 v[84:87], v[52:55], v[188:191], v[84:87]
  s_waitcnt lgkmcnt(8)
  ds_read_b128 a[252:255], v2 offset:52224
  v_fma_f32 v65, v65, v6, v6
  v_fma_f32 v66, v66, v6, v6
  v_mfma_f32_16x16x32_bf16 v[92:95], v[56:59], v[180:183], v[92:95]
  ds_read_b128 v[48:51], v2 offset:20480
  v_rcp_f32 v65, v65
  v_mfma_f32_16x16x32_bf16 v[92:95], v[60:63], v[188:191], v[92:95]
  s_waitcnt vmcnt(15) lgkmcnt(8)
  ds_read_b128 v[52:55], v2 offset:22528
  buffer_load_dwordx4 v2, s[12:15], s60 offen offset:1024 sc1 lds
  v_mfma_f32_16x16x32_bf16 v[68:71], a[224:227], v[196:199], v[68:71]
  ds_read_b128 v[56:59], v2 offset:21504
  v_rcp_f32 v66, v66
  v_mfma_f32_16x16x32_bf16 v[68:71], a[228:231], v[204:207], v[68:71]
  s_waitcnt lgkmcnt(8)
  ds_read_b128 v[60:63], v2 offset:23552
  v_fma_f32 v67, v67, v6, v6
  v_mul_f32 v72, v72, v64
  v_mfma_f32_16x16x32_bf16 v[76:79], a[232:235], v[196:199], v[76:79]
  ds_read_b128 a[224:227], v2 offset:53248
  v_rcp_f32 v67, v67
  v_mfma_f32_16x16x32_bf16 v[76:79], a[236:239], v[204:207], v[76:79]
  s_waitcnt lgkmcnt(8)
  ds_read_b128 a[228:231], v2 offset:55296
  v_mul_f32 v73, v73, v65
  v_mul_f32 v74, v74, v66
  v_mfma_f32_16x16x32_bf16 v[84:87], a[240:243], v[196:199], v[84:87]
  ds_read_b128 a[232:235], v2 offset:54272
  buffer_load_dwordx4 v2, s[12:15], s60 offen offset:2048 sc1 lds
  v_mfma_f32_16x16x32_bf16 v[84:87], a[244:247], v[204:207], v[84:87]
  s_waitcnt lgkmcnt(7)
  ds_read_b128 a[236:239], v2 offset:56320
  v_mul_f32 v75, v75, v67
  v_fmac_f32 v80, v16, v4
  v_mfma_f32_16x16x32_bf16 v[92:95], a[248:251], v[196:199], v[92:95]
  ds_read_b128 a[240:243], v2 offset:24576
  v_fmac_f32 v81, v17, v4
  v_fmac_f32 v82, v18, v4
  v_mfma_f32_16x16x32_bf16 v[92:95], a[252:255], v[204:207], v[92:95]
  s_waitcnt vmcnt(15) lgkmcnt(7)
  ds_read_b128 a[244:247], v2 offset:26624
  v_fmac_f32 v83, v19, v4
  v_mul_f32 v80, v80, v5
  v_mfma_f32_16x16x32_bf16 v[68:71], v[48:51], v[212:215], v[68:71]
  ds_read_b128 a[248:251], v2 offset:25600
  ds_read_b128 v[16:19], v8 offset:0
  v_mul_f32 v81, v81, v5
  v_mfma_f32_16x16x32_bf16 v[68:71], v[52:55], v[220:223], v[68:71]
  s_waitcnt lgkmcnt(8)
  ds_read_b128 a[252:255], v2 offset:27648
  buffer_load_dwordx4 v2, s[12:15], s60 offen offset:3072 sc1 lds
  v_mfma_f32_16x16x32_bf16 v[76:79], v[56:59], v[212:215], v[76:79]
  s_add_u32 m0, s51, 135168
  ds_read_b128 v[48:51], v2 offset:57344
  v_exp_f32 v80, v80
  v_mfma_f32_16x16x32_bf16 v[76:79], v[60:63], v[220:223], v[76:79]
  s_waitcnt lgkmcnt(8)
  ds_read_b128 v[52:55], v2 offset:59392
  v_exp_f32 v81, v81
  v_mfma_f32_16x16x32_bf16 v[84:87], a[224:227], v[212:215], v[84:87]
  s_add_u32 s60, s50, 102400
  ds_read_b128 v[56:59], v2 offset:58368
  v_mul_f32 v82, v82, v5
  v_mul_f32 v83, v83, v5
  v_mfma_f32_16x16x32_bf16 v[84:87], a[228:231], v[220:223], v[84:87]
  s_waitcnt lgkmcnt(8)
  ds_read_b128 v[60:63], v2 offset:60416
  v_exp_f32 v82, v82
  v_mfma_f32_16x16x32_bf16 v[92:95], a[232:235], v[212:215], v[92:95]
  ds_read_b128 a[224:227], v2 offset:28672
  buffer_load_dwordx4 v2, s[12:15], s60 offen offset:0 sc1 lds
  v_mfma_f32_16x16x32_bf16 v[92:95], a[236:239], v[220:223], v[92:95]
  s_waitcnt vmcnt(15) lgkmcnt(8)
  ds_read_b128 a[228:231], v2 offset:30720
  v_exp_f32 v83, v83
  v_mfma_f32_16x16x32_bf16 v[68:71], a[240:243], v[228:231], v[68:71]
  ds_read_b128 a[232:235], v2 offset:29696
  v_fmac_f32 v88, v20, v4
  v_fmac_f32 v89, v21, v4
  v_mfma_f32_16x16x32_bf16 v[68:71], a[244:247], v[236:239], v[68:71]
  s_waitcnt lgkmcnt(7)
  ds_read_b128 a[236:239], v2 offset:31744
  v_fmac_f32 v90, v22, v4
  v_fmac_f32 v91, v23, v4
  v_mfma_f32_16x16x32_bf16 v[76:79], a[248:251], v[228:231], v[76:79]
  ds_read_b128 a[240:243], v2 offset:61440
  ds_read_b128 v[20:23], v8 offset:64
  buffer_load_dwordx4 v2, s[12:15], s60 offen offset:1024 sc1 lds
  v_mfma_f32_16x16x32_bf16 v[76:79], a[252:255], v[236:239], v[76:79]
  s_waitcnt lgkmcnt(8)
  ds_read_b128 a[244:247], v2 offset:63488
  v_fma_f32 v80, v80, v6, v6
  v_fma_f32 v81, v81, v6, v6
  v_mfma_f32_16x16x32_bf16 v[84:87], v[48:51], v[228:231], v[84:87]
  ds_read_b128 a[248:251], v2 offset:62464
  v_rcp_f32 v80, v80
  v_mfma_f32_16x16x32_bf16 v[84:87], v[52:55], v[236:239], v[84:87]
  s_waitcnt lgkmcnt(8)
  ds_read_b128 a[252:255], v2 offset:64512
  v_rcp_f32 v81, v81
  v_mfma_f32_16x16x32_bf16 v[92:95], v[56:59], v[228:231], v[92:95]
  ds_read_b128 v[48:51], v12 offset:0
  v_mfma_f32_16x16x32_bf16 v[92:95], v[60:63], v[236:239], v[92:95]
  s_waitcnt vmcnt(14) lgkmcnt(8)
  ds_read_b128 v[52:55], v12 offset:2048
  buffer_load_dwordx4 v2, s[12:15], s60 offen offset:2048 sc1 lds
  v_mfma_f32_16x16x32_bf16 v[68:71], a[224:227], v[244:247], v[68:71]
  ds_read_b128 v[56:59], v12 offset:1024
  v_fma_f32 v82, v82, v6, v6
  v_fma_f32 v83, v83, v6, v6
  v_mfma_f32_16x16x32_bf16 v[68:71], a[228:231], v[252:255], v[68:71]
  s_waitcnt lgkmcnt(8)
  ds_read_b128 v[60:63], v12 offset:3072
  v_rcp_f32 v82, v82
  v_mfma_f32_16x16x32_bf16 v[76:79], a[232:235], v[244:247], v[76:79]
  v_rcp_f32 v83, v83
  v_mul_f32 v88, v88, v80
  v_mfma_f32_16x16x32_bf16 v[76:79], a[236:239], v[252:255], v[76:79]
  s_waitcnt lgkmcnt(6)
  v_mul_f32 v89, v89, v81
  v_mul_f32 v90, v90, v82
  v_mul_f32 v91, v91, v83
  v_mfma_f32_16x16x32_bf16 v[84:87], a[240:243], v[244:247], v[84:87]
  ds_read_b128 a[224:227], v12 offset:4096
  buffer_load_dwordx4 v2, s[12:15], s60 offen offset:3072 sc1 lds
  v_mfma_f32_16x16x32_bf16 v[84:87], a[244:247], v[252:255], v[84:87]
  s_waitcnt lgkmcnt(5)
  ds_read_b128 a[228:231], v12 offset:6144
  s_waitcnt vmcnt(8)
  v_add_f32 v120, v120, v127
  v_add_f32 v120, v120, v126
  v_mfma_f32_16x16x32_bf16 v[92:95], a[248:251], v[244:247], v[92:95]
  v_add_f32 v120, v120, v125
  v_add_f32 v120, v120, v124
  v_add_f32 v120, v120, v123
  v_mfma_f32_16x16x32_bf16 v[92:95], a[252:255], v[252:255], v[92:95]
  s_waitcnt lgkmcnt(4)
  v_add_f32 v120, v120, v122
  v_add_f32 v120, v120, v121
  v_mov_b32 v121, v120
  v_mfma_f32_16x16x32_bf16 v[96:99], v[48:51], v[128:131], 0
  ds_read_b128 a[232:235], v12 offset:5120
  v_mov_b32 v123, 0x3b000000
  v_mfma_f32_16x16x32_bf16 v[96:99], v[52:55], v[136:139], v[96:99]
  ds_read_b128 a[236:239], v12 offset:7168
  buffer_load_dwordx4 a[76:79], v2, s[12:15], s57 offen offset:3072 sc1
  v_mfma_f32_16x16x32_bf16 v[100:103], v[48:51], v[132:135], 0
  s_add_u32 s57, s49, 20480
  v_permlane32_swap_b32 v120, v121
  v_add_f32 v120, v120, v121
  v_mfma_f32_16x16x32_bf16 v[100:103], v[52:55], v[140:143], v[100:103]
  s_waitcnt lgkmcnt(4)
  v_mov_b32 v121, v120
  v_mfma_f32_16x16x32_bf16 v[104:107], v[56:59], v[128:131], 0
  ds_read_b128 a[240:243], v12 offset:8192
  v_permlane16_swap_b32 v120, v121
  v_mfma_f32_16x16x32_bf16 v[104:107], v[60:63], v[136:139], v[104:107]
  ds_read_b128 a[244:247], v12 offset:10240
  v_mul_f32 v24, 0xbb000000, v120
  v_mfma_f32_16x16x32_bf16 v[108:111], v[56:59], v[132:135], 0
  buffer_load_dwordx4 a[80:83], v2, s[12:15], s57 offen offset:0 sc1
  v_mfma_f32_16x16x32_bf16 v[108:111], v[60:63], v[140:143], v[108:111]
  s_waitcnt lgkmcnt(4)
  v_mul_f32 v122, v24, v24
  v_fma_f32 v121, v121, v123, -v122
  v_max_f32 v121, 0, v121
  v_mfma_f32_16x16x32_bf16 v[96:99], a[224:227], v[144:147], v[96:99]
  ds_read_b128 a[248:251], v12 offset:9216
  v_add_f32 v121, 0x3727c5ac, v121
  v_mfma_f32_16x16x32_bf16 v[96:99], a[228:231], v[152:155], v[96:99]
  ds_read_b128 a[252:255], v12 offset:11264
  v_fmac_f32 v68, v16, v24
  v_mfma_f32_16x16x32_bf16 v[100:103], a[224:227], v[148:151], v[100:103]
  buffer_load_dwordx4 a[84:87], v2, s[12:15], s57 offen offset:1024 sc1
  v_mfma_f32_16x16x32_bf16 v[100:103], a[228:231], v[156:159], v[100:103]
  s_waitcnt lgkmcnt(4)
  v_rsq_f32 v25, v121
  v_fmac_f32 v69, v17, v24
  v_mfma_f32_16x16x32_bf16 v[104:107], a[232:235], v[144:147], v[104:107]
  ds_read_b128 v[48:51], v12 offset:12288
  v_mul_f32 v25, 0xbfb8aa3b, v25
  v_mfma_f32_16x16x32_bf16 v[104:107], a[236:239], v[152:155], v[104:107]
  ds_read_b128 v[52:55], v12 offset:14336
  v_fmac_f32 v70, v18, v24
  v_mfma_f32_16x16x32_bf16 v[108:111], a[232:235], v[148:151], v[108:111]
  v_sqrt_f32 v26, v121
  v_mfma_f32_16x16x32_bf16 v[108:111], a[236:239], v[156:159], v[108:111]
  s_waitcnt lgkmcnt(4)
  buffer_load_dwordx4 a[88:91], v2, s[12:15], s57 offen offset:2048 sc1
  v_fmac_f32 v71, v19, v24
  v_mfma_f32_16x16x32_bf16 v[96:99], a[240:243], v[160:163], v[96:99]
  ds_read_b128 v[56:59], v12 offset:13312
  ds_read_b128 v[16:19], v8 offset:128
  v_mfma_f32_16x16x32_bf16 v[96:99], a[244:247], v[168:171], v[96:99]
  ds_read_b128 v[60:63], v12 offset:15360
  v_mul_f32 v68, v68, v25
  v_mfma_f32_16x16x32_bf16 v[100:103], a[240:243], v[164:167], v[100:103]
  v_exp_f32 v68, v68
  v_mfma_f32_16x16x32_bf16 v[100:103], a[244:247], v[172:175], v[100:103]
  s_waitcnt lgkmcnt(5)
  v_mul_f32 v69, v69, v25
  v_exp_f32 v69, v69
  v_mfma_f32_16x16x32_bf16 v[104:107], a[248:251], v[160:163], v[104:107]
  ds_read_b128 a[224:227], v12 offset:16384
  buffer_load_dwordx4 a[92:95], v2, s[12:15], s57 offen offset:3072 sc1
  v_mfma_f32_16x16x32_bf16 v[104:107], a[252:255], v[168:171], v[104:107]
  s_add_u32 s57, s49, 24576
  ds_read_b128 a[228:231], v12 offset:18432
  v_mul_f32 v70, v70, v25
  v_mfma_f32_16x16x32_bf16 v[108:111], a[248:251], v[164:167], v[108:111]
  v_exp_f32 v70, v70
  v_mfma_f32_16x16x32_bf16 v[108:111], a[252:255], v[172:175], v[108:111]
  s_waitcnt lgkmcnt(5)
  v_mul_f32 v71, v71, v25
  v_exp_f32 v71, v71
  v_mfma_f32_16x16x32_bf16 v[96:99], v[48:51], v[176:179], v[96:99]
  ds_read_b128 a[232:235], v12 offset:17408
  v_fmac_f32 v76, v20, v24
  v_mfma_f32_16x16x32_bf16 v[96:99], v[52:55], v[184:187], v[96:99]
  ds_read_b128 a[236:239], v12 offset:19456
  buffer_load_dwordx4 a[96:99], v2, s[12:15], s57 offen offset:0 sc1
  v_mfma_f32_16x16x32_bf16 v[100:103], v[48:51], v[180:183], v[100:103]
  v_fmac_f32 v77, v21, v24
  v_fmac_f32 v78, v22, v24
  v_mfma_f32_16x16x32_bf16 v[100:103], v[52:55], v[188:191], v[100:103]
  s_waitcnt lgkmcnt(4)
  v_fmac_f32 v79, v23, v24
  v_fma_f32 v68, v68, v26, v26
  v_fma_f32 v69, v69, v26, v26
  v_mfma_f32_16x16x32_bf16 v[104:107], v[56:59], v[176:179], v[104:107]
  ds_read_b128 a[240:243], v12 offset:20480
  ds_read_b128 v[20:23], v8 offset:192
  v_mfma_f32_16x16x32_bf16 v[104:107], v[60:63], v[184:187], v[104:107]
  ds_read_b128 a[244:247], v12 offset:22528
  buffer_load_dwordx4 a[100:103], v2, s[12:15], s57 offen offset:1024 sc1
  v_mfma_f32_16x16x32_bf16 v[108:111], v[56:59], v[180:183], v[108:111]
  v_rcp_f32 v68, v68
  v_mfma_f32_16x16x32_bf16 v[108:111], v[60:63], v[188:191], v[108:111]
  s_waitcnt lgkmcnt(5)
  v_rcp_f32 v69, v69
  v_fma_f32 v70, v70, v26, v26
  v_mfma_f32_16x16x32_bf16 v[96:99], a[224:227], v[192:195], v[96:99]
  ds_read_b128 a[248:251], v12 offset:21504
  v_fma_f32 v71, v71, v26, v26
  v_mfma_f32_16x16x32_bf16 v[96:99], a[228:231], v[200:203], v[96:99]
  ds_read_b128 a[252:255], v12 offset:23552
  v_mul_f32 v76, v76, v68
  v_mfma_f32_16x16x32_bf16 v[100:103], a[224:227], v[196:199], v[100:103]
  buffer_load_dwordx4 a[104:107], v2, s[12:15], s57 offen offset:2048 sc1
  v_mfma_f32_16x16x32_bf16 v[100:103], a[228:231], v[204:207], v[100:103]
  s_waitcnt lgkmcnt(5)
  v_rcp_f32 v70, v70
  v_mul_f32 v77, v77, v69
  v_mfma_f32_16x16x32_bf16 v[104:107], a[232:235], v[192:195], v[104:107]
  ds_read_b128 v[48:51], v12 offset:24576
  s_waitcnt vmcnt(8)
  s_barrier
  v_mfma_f32_16x16x32_bf16 v[104:107], a[236:239], v[200:203], v[104:107]
  s_add_u32 m0, s51, 0
  ds_read_b128 v[52:55], v12 offset:26624
  v_mul_f32 v78, v78, v70
  v_mfma_f32_16x16x32_bf16 v[108:111], a[232:235], v[196:199], v[108:111]
  s_add_u32 s60, s50, 131072
  v_rcp_f32 v71, v71
  v_mfma_f32_16x16x32_bf16 v[108:111], a[236:239], v[204:207], v[108:111]
  s_waitcnt lgkmcnt(4)
  buffer_load_dwordx4 v2, s[12:15], s60 offen offset:0 sc1 lds
  v_cvt_pk_bf16_f32 v36, v72, v73
  v_mfma_f32_16x16x32_bf16 v[96:99], a[240:243], v[208:211], v[96:99]
  ds_read_b128 v[56:59], v12 offset:25600
  v_mul_f32 v79, v79, v71
  v_mfma_f32_16x16x32_bf16 v[96:99], a[244:247], v[216:219], v[96:99]
  ds_read_b128 v[60:63], v12 offset:27648
  v_cvt_pk_bf16_f32 v38, v76, v77
  v_mfma_f32_16x16x32_bf16 v[100:103], a[240:243], v[212:215], v[100:103]
  v_cvt_pk_bf16_f32 v37, v74, v75
  v_cvt_pk_bf16_f32 v39, v78, v79
  v_mfma_f32_16x16x32_bf16 v[100:103], a[244:247], v[220:223], v[100:103]
  s_waitcnt lgkmcnt(4)
  v_permlane16_swap_b32 v36, v38
  v_permlane16_swap_b32 v37, v39
  v_fmac_f32 v84, v16, v24
  v_mfma_f32_16x16x32_bf16 v[104:107], a[248:251], v[208:211], v[104:107]
  ds_read_b128 a[224:227], v12 offset:28672
  buffer_load_dwordx4 v2, s[12:15], s60 offen offset:1024 sc1 lds
  v_mfma_f32_16x16x32_bf16 v[104:107], a[252:255], v[216:219], v[104:107]
  ds_read_b128 a[228:231], v12 offset:30720
  v_fmac_f32 v85, v17, v24
  v_mfma_f32_16x16x32_bf16 v[108:111], a[248:251], v[212:215], v[108:111]
  buffer_store_dwordx4 v[36:39], v7, s[12:15], s64 offen offset:0 sc1
  v_mfma_f32_16x16x32_bf16 v[108:111], a[252:255], v[220:223], v[108:111]
  s_waitcnt lgkmcnt(4)
  v_fmac_f32 v86, v18, v24
  v_fmac_f32 v87, v19, v24
  v_mul_f32 v84, v84, v25
  v_mfma_f32_16x16x32_bf16 v[96:99], v[48:51], v[224:227], v[96:99]
  ds_read_b128 a[232:235], v12 offset:29696
  ds_read_b128 v[16:19], v8 offset:256
  v_mfma_f32_16x16x32_bf16 v[96:99], v[52:55], v[232:235], v[96:99]
  ds_read_b128 a[236:239], v12 offset:31744
  buffer_load_dwordx4 v2, s[12:15], s60 offen offset:2048 sc1 lds
  v_mfma_f32_16x16x32_bf16 v[100:103], v[48:51], v[228:231], v[100:103]
  v_exp_f32 v84, v84
  v_mfma_f32_16x16x32_bf16 v[100:103], v[52:55], v[236:239], v[100:103]
  s_waitcnt lgkmcnt(5)
  v_mul_f32 v85, v85, v25
  v_exp_f32 v85, v85
  v_mfma_f32_16x16x32_bf16 v[104:107], v[56:59], v[224:227], v[104:107]
  ds_read_b128 a[240:243], v12 offset:32768
  v_mfma_f32_16x16x32_bf16 v[104:107], v[60:63], v[232:235], v[104:107]
  ds_read_b128 a[244:247], v12 offset:34816
  buffer_load_dwordx4 v2, s[12:15], s60 offen offset:3072 sc1 lds
  v_mfma_f32_16x16x32_bf16 v[108:111], v[56:59], v[228:231], v[108:111]
  s_add_u32 m0, s51, 4096
  v_mul_f32 v86, v86, v25
  v_mul_f32 v87, v87, v25
  v_mfma_f32_16x16x32_bf16 v[108:111], v[60:63], v[236:239], v[108:111]
  s_waitcnt lgkmcnt(5)
  v_exp_f32 v86, v86
  v_fmac_f32 v92, v20, v24
  v_mfma_f32_16x16x32_bf16 v[96:99], a[224:227], v[240:243], v[96:99]
  s_add_u32 s60, s50, 135168
  ds_read_b128 a[248:251], v12 offset:33792
  v_fmac_f32 v93, v21, v24
  v_mfma_f32_16x16x32_bf16 v[96:99], a[228:231], v[248:251], v[96:99]
  ds_read_b128 a[252:255], v12 offset:35840
  v_fmac_f32 v94, v22, v24
  v_mfma_f32_16x16x32_bf16 v[100:103], a[224:227], v[244:247], v[100:103]
  buffer_load_dwordx4 v2, s[12:15], s60 offen offset:0 sc1 lds
  v_mfma_f32_16x16x32_bf16 v[100:103], a[228:231], v[252:255], v[100:103]
  s_waitcnt lgkmcnt(4)
  v_exp_f32 v87, v87
  v_fmac_f32 v95, v23, v24
  v_mfma_f32_16x16x32_bf16 v[104:107], a[232:235], v[240:243], v[104:107]
  ds_read_b128 v[48:51], v12 offset:36864
  ds_read_b128 v[20:23], v8 offset:320
  v_mfma_f32_16x16x32_bf16 v[104:107], a[236:239], v[248:251], v[104:107]
  ds_read_b128 v[52:55], v12 offset:38912
  v_fma_f32 v84, v84, v26, v26
  v_mfma_f32_16x16x32_bf16 v[108:111], a[232:235], v[244:247], v[108:111]
  v_rcp_f32 v84, v84
  v_mfma_f32_16x16x32_bf16 v[108:111], a[236:239], v[252:255], v[108:111]
  s_waitcnt lgkmcnt(5)
  buffer_load_dwordx4 v2, s[12:15], s60 offen offset:1024 sc1 lds
  v_fma_f32 v85, v85, v26, v26
  v_mfma_f32_16x16x32_bf16 v[112:115], a[240:243], v[128:131], 0
  ds_read_b128 v[56:59], v12 offset:37888
  v_fma_f32 v86, v86, v26, v26
  v_mfma_f32_16x16x32_bf16 v[112:115], a[244:247], v[136:139], v[112:115]
  ds_read_b128 v[60:63], v12 offset:39936
  v_fma_f32 v87, v87, v26, v26
  v_mfma_f32_16x16x32_bf16 v[116:119], a[240:243], v[132:135], 0
  v_rcp_f32 v85, v85
  v_mfma_f32_16x16x32_bf16 v[116:119], a[244:247], v[140:143], v[116:119]
  s_waitcnt lgkmcnt(5)
  buffer_load_dwordx4 v2, s[12:15], s60 offen offset:2048 sc1 lds
  v_mul_f32 v92, v92, v84
  v_mfma_f32_16x16x32_bf16 v[120:123], a[248:251], v[128:131], 0
  ds_read_b128 a[224:227], v12 offset:40960
  v_mul_f32 v93, v93, v85
  v_mfma_f32_16x16x32_bf16 v[120:123], a[252:255], v[136:139], v[120:123]
  ds_read_b128 a[228:231], v12 offset:43008
  v_cvt_pk_bf16_f32 v36, v88, v89
  v_mfma_f32_16x16x32_bf16 v[124:127], a[248:251], v[132:135], 0
  v_rcp_f32 v86, v86
  v_mfma_f32_16x16x32_bf16 v[124:127], a[252:255], v[140:143], v[124:127]
  s_waitcnt lgkmcnt(4)
  v_rcp_f32 v87, v87
  v_mul_f32 v94, v94, v86
  v_mfma_f32_16x16x32_bf16 v[112:115], v[48:51], v[144:147], v[112:115]
  ds_read_b128 a[232:235], v12 offset:41984
  buffer_load_dwordx4 v2, s[12:15], s60 offen offset:3072 sc1 lds
  v_mfma_f32_16x16x32_bf16 v[112:115], v[52:55], v[152:155], v[112:115]
  s_add_u32 m0, s51, 32768
  ds_read_b128 a[236:239], v12 offset:44032
  v_mul_f32 v95, v95, v87
  v_mfma_f32_16x16x32_bf16 v[116:119], v[48:51], v[148:151], v[116:119]
  s_add_u32 s60, s50, 163840
  v_cvt_pk_bf16_f32 v38, v92, v93
  v_cvt_pk_bf16_f32 v37, v90, v91
  v_mfma_f32_16x16x32_bf16 v[116:119], v[52:55], v[156:159], v[116:119]
  s_waitcnt lgkmcnt(4)
  v_cvt_pk_bf16_f32 v39, v94, v95
  v_permlane16_swap_b32 v36, v38
  v_fmac_f32 v96, v16, v4
  v_mfma_f32_16x16x32_bf16 v[120:123], v[56:59], v[144:147], v[120:123]
  ds_read_b128 a[240:243], v12 offset:45056
  v_permlane16_swap_b32 v37, v39
  v_mfma_f32_16x16x32_bf16 v[120:123], v[60:63], v[152:155], v[120:123]
  ds_read_b128 a[244:247], v12 offset:47104
  buffer_load_dwordx4 v2, s[12:15], s60 offen offset:0 sc1 lds
  v_mfma_f32_16x16x32_bf16 v[124:127], v[56:59], v[148:151], v[124:127]
  buffer_store_dwordx4 v[36:39], v7, s[12:15], s64 offen offset:1024 sc1
  v_mfma_f32_16x16x32_bf16 v[124:127], v[60:63], v[156:159], v[124:127]
  s_waitcnt lgkmcnt(4)
  v_fmac_f32 v97, v17, v4
  v_fmac_f32 v98, v18, v4
  v_fmac_f32 v99, v19, v4
  v_mfma_f32_16x16x32_bf16 v[112:115], a[224:227], v[160:163], v[112:115]
  ds_read_b128 a[248:251], v12 offset:46080
  v_fmac_f32 v100, v16, v24
  v_mfma_f32_16x16x32_bf16 v[112:115], a[228:231], v[168:171], v[112:115]
  ds_read_b128 a[252:255], v12 offset:48128
  v_fmac_f32 v101, v17, v24
  v_mfma_f32_16x16x32_bf16 v[116:119], a[224:227], v[164:167], v[116:119]
  buffer_load_dwordx4 v2, s[12:15], s60 offen offset:1024 sc1 lds
  v_mfma_f32_16x16x32_bf16 v[116:119], a[228:231], v[172:175], v[116:119]
  s_waitcnt lgkmcnt(4)
  v_fmac_f32 v102, v18, v24
  v_fmac_f32 v103, v19, v24
  v_mul_f32 v96, v96, v5
  v_mfma_f32_16x16x32_bf16 v[120:123], a[232:235], v[160:163], v[120:123]
  ds_read_b128 v[48:51], v12 offset:49152
  ds_read_b128 v[16:19], v8 offset:384
  v_mfma_f32_16x16x32_bf16 v[120:123], a[236:239], v[168:171], v[120:123]
  ds_read_b128 v[52:55], v12 offset:51200
  v_mul_f32 v97, v97, v5
  v_mfma_f32_16x16x32_bf16 v[124:127], a[232:235], v[164:167], v[124:127]
  v_exp_f32 v96, v96
  v_mfma_f32_16x16x32_bf16 v[124:127], a[236:239], v[172:175], v[124:127]
  s_waitcnt lgkmcnt(5)
  buffer_load_dwordx4 v2, s[12:15], s60 offen offset:2048 sc1 lds
  v_mul_f32 v98, v98, v5
  v_mfma_f32_16x16x32_bf16 v[112:115], a[240:243], v[176:179], v[112:115]
  ds_read_b128 v[56:59], v12 offset:50176
  v_mul_f32 v99, v99, v5
  v_mfma_f32_16x16x32_bf16 v[112:115], a[244:247], v[184:187], v[112:115]
  ds_read_b128 v[60:63], v12 offset:52224
  v_mul_f32 v100, v100, v25
  v_mfma_f32_16x16x32_bf16 v[116:119], a[240:243], v[180:183], v[116:119]
  v_exp_f32 v97, v97
  v_mfma_f32_16x16x32_bf16 v[116:119], a[244:247], v[188:191], v[116:119]
  s_waitcnt lgkmcnt(5)
  buffer_load_dwordx4 v2, s[12:15], s60 offen offset:3072 sc1 lds
  v_mul_f32 v101, v101, v25
  v_mfma_f32_16x16x32_bf16 v[120:123], a[248:251], v[176:179], v[120:123]
  s_add_u32 m0, s51, 36864
  ds_read_b128 a[224:227], v12 offset:53248
  v_mul_f32 v102, v102, v25
  v_mfma_f32_16x16x32_bf16 v[120:123], a[252:255], v[184:187], v[120:123]
  s_add_u32 s60, s50, 167936
  ds_read_b128 a[228:231], v12 offset:55296
  v_mul_f32 v103, v103, v25
  v_mfma_f32_16x16x32_bf16 v[124:127], a[248:251], v[180:183], v[124:127]
  v_exp_f32 v98, v98
  v_mfma_f32_16x16x32_bf16 v[124:127], a[252:255], v[188:191], v[124:127]
  s_waitcnt lgkmcnt(4)
  v_exp_f32 v99, v99
  v_fmac_f32 v104, v20, v4
  v_mfma_f32_16x16x32_bf16 v[112:115], v[48:51], v[192:195], v[112:115]
  ds_read_b128 a[232:235], v12 offset:54272
  buffer_load_dwordx4 v2, s[12:15], s60 offen offset:0 sc1 lds
  v_mfma_f32_16x16x32_bf16 v[112:115], v[52:55], v[200:203], v[112:115]
  ds_read_b128 a[236:239], v12 offset:56320
  v_fmac_f32 v105, v21, v4
  v_mfma_f32_16x16x32_bf16 v[116:119], v[48:51], v[196:199], v[116:119]
  v_exp_f32 v100, v100
  v_mfma_f32_16x16x32_bf16 v[116:119], v[52:55], v[204:207], v[116:119]
  s_waitcnt lgkmcnt(4)
  v_exp_f32 v101, v101
  v_fmac_f32 v106, v22, v4
  v_mfma_f32_16x16x32_bf16 v[120:123], v[56:59], v[192:195], v[120:123]
  ds_read_b128 a[240:243], v12 offset:57344
  v_fmac_f32 v107, v23, v4
  v_mfma_f32_16x16x32_bf16 v[120:123], v[60:63], v[200:203], v[120:123]
  ds_read_b128 a[244:247], v12 offset:59392
  buffer_load_dwordx4 v2, s[12:15], s60 offen offset:1024 sc1 lds
  v_mfma_f32_16x16x32_bf16 v[124:127], v[56:59], v[196:199], v[124:127]
  v_exp_f32 v102, v102
  v_mfma_f32_16x16x32_bf16 v[124:127], v[60:63], v[204:207], v[124:127]
  s_waitcnt lgkmcnt(4)
  v_exp_f32 v103, v103
  v_fmac_f32 v108, v20, v24
  v_mfma_f32_16x16x32_bf16 v[112:115], a[224:227], v[208:211], v[112:115]
  ds_read_b128 a[248:251], v12 offset:58368
  v_fmac_f32 v109, v21, v24
  v_mfma_f32_16x16x32_bf16 v[112:115], a[228:231], v[216:219], v[112:115]
  ds_read_b128 a[252:255], v12 offset:60416
  v_fmac_f32 v110, v22, v24
  v_mfma_f32_16x16x32_bf16 v[116:119], a[224:227], v[212:215], v[116:119]
  buffer_load_dwordx4 v2, s[12:15], s60 offen offset:2048 sc1 lds
  v_mfma_f32_16x16x32_bf16 v[116:119], a[228:231], v[220:223], v[116:119]
  s_waitcnt lgkmcnt(4)
  v_fmac_f32 v111, v23, v24
  v_fma_f32 v96, v96, v6, v6
  v_fma_f32 v97, v97, v6, v6
  v_mfma_f32_16x16x32_bf16 v[120:123], a[232:235], v[208:211], v[120:123]
  ds_read_b128 v[48:51], v12 offset:61440
  ds_read_b128 v[20:23], v8 offset:448
  v_mfma_f32_16x16x32_bf16 v[120:123], a[236:239], v[216:219], v[120:123]
  ds_read_b128 v[52:55], v12 offset:63488
  v_fma_f32 v98, v98, v6, v6
  v_mfma_f32_16x16x32_bf16 v[124:127], a[232:235], v[212:215], v[124:127]
  buffer_load_dwordx4 v2, s[12:15], s60 offen offset:3072 sc1 lds
  v_mfma_f32_16x16x32_bf16 v[124:127], a[236:239], v[220:223], v[124:127]
  s_waitcnt lgkmcnt(5)
  v_rcp_f32 v96, v96
  v_fma_f32 v99, v99, v6, v6
  v_mfma_f32_16x16x32_bf16 v[112:115], a[240:243], v[224:227], v[112:115]
  ds_read_b128 v[56:59], v12 offset:62464
  v_fma_f32 v100, v100, v26, v26
  v_mfma_f32_16x16x32_bf16 v[112:115], a[244:247], v[232:235], v[112:115]
  ds_read_b128 v[60:63], v12 offset:64512
  v_fma_f32 v101, v101, v26, v26
  v_mfma_f32_16x16x32_bf16 v[116:119], a[240:243], v[228:231], v[116:119]
  v_rcp_f32 v97, v97
  v_mfma_f32_16x16x32_bf16 v[116:119], a[244:247], v[236:239], v[116:119]
  s_waitcnt lgkmcnt(5)
  buffer_load_dwordx4 a[108:111], v2, s[12:15], s57 offen offset:3072 sc1
  v_fma_f32 v102, v102, v26, v26
  v_mfma_f32_16x16x32_bf16 v[120:123], a[248:251], v[224:227], v[120:123]
  s_add_u32 s57, s49, 28672
  s_waitcnt vmcnt(10)
  s_barrier
  ds_read_b128 a[224:227], v2 offset:0
  v_mfma_f32_16x16x32_bf16 v[120:123], a[252:255], v[232:235], v[120:123]
  s_add_u32 m0, s51, 98304
  ds_read_b128 a[228:231], v2 offset:2048
  v_fma_f32 v103, v103, v26, v26
  v_mfma_f32_16x16x32_bf16 v[124:127], a[248:251], v[228:231], v[124:127]
  s_add_u32 s60, s50, 196608
  v_rcp_f32 v98, v98
  v_mfma_f32_16x16x32_bf16 v[124:127], a[252:255], v[236:239], v[124:127]
  s_waitcnt lgkmcnt(4)
  v_rcp_f32 v99, v99
  v_mul_f32 v104, v104, v96
  v_mfma_f32_16x16x32_bf16 v[112:115], v[48:51], v[240:243], v[112:115]
  ds_read_b128 a[232:235], v2 offset:1024
  buffer_load_dwordx4 v2, s[12:15], s60 offen offset:0 sc1 lds
  v_mfma_f32_16x16x32_bf16 v[112:115], v[52:55], v[248:251], v[112:115]
  ds_read_b128 a[236:239], v2 offset:3072
  v_mul_f32 v105, v105, v97
  v_mfma_f32_16x16x32_bf16 v[116:119], v[48:51], v[244:247], v[116:119]
  v_rcp_f32 v100, v100
  v_mfma_f32_16x16x32_bf16 v[116:119], v[52:55], v[252:255], v[116:119]
  s_waitcnt lgkmcnt(4)
  v_rcp_f32 v101, v101
  v_mul_f32 v106, v106, v98
  v_mfma_f32_16x16x32_bf16 v[120:123], v[56:59], v[240:243], v[120:123]
  ds_read_b128 a[240:243], v2 offset:4096
  v_mul_f32 v107, v107, v99
  v_mfma_f32_16x16x32_bf16 v[120:123], v[60:63], v[248:251], v[120:123]
  ds_read_b128 a[244:247], v2 offset:6144
  buffer_load_dwordx4 v2, s[12:15], s60 offen offset:1024 sc1 lds
  v_mfma_f32_16x16x32_bf16 v[124:127], v[56:59], v[244:247], v[124:127]
  v_rcp_f32 v102, v102
  v_mfma_f32_16x16x32_bf16 v[124:127], v[60:63], v[252:255], v[124:127]
  s_waitcnt lgkmcnt(4)
  v_rcp_f32 v103, v103
  v_mul_f32 v108, v108, v100
  v_mfma_f32_16x16x32_bf16 v[64:67], a[224:227], v[128:131], 0
  ds_read_b128 a[248:251], v2 offset:5120
  v_mul_f32 v109, v109, v101
  v_mfma_f32_16x16x32_bf16 v[64:67], a[228:231], v[136:139], v[64:67]
  ds_read_b128 a[252:255], v2 offset:7168
  buffer_load_dwordx4 v2, s[12:15], s60 offen offset:2048 sc1 lds
  v_mfma_f32_16x16x32_bf16 v[68:71], a[224:227], v[132:135], 0
  v_mul_f32 v110, v110, v102
  v_cvt_pk_bf16_f32 v36, v104, v105
  v_mfma_f32_16x16x32_bf16 v[68:71], a[228:231], v[140:143], v[68:71]
  s_waitcnt lgkmcnt(4)
  v_mul_f32 v111, v111, v103
  v_cvt_pk_bf16_f32 v38, v108, v109
  v_cvt_pk_bf16_f32 v37, v106, v107
  v_mfma_f32_16x16x32_bf16 v[72:75], a[232:235], v[128:131], 0
  ds_read_b128 v[48:51], v2 offset:8192
  v_cvt_pk_bf16_f32 v39, v110, v111
  v_mfma_f32_16x16x32_bf16 v[72:75], a[236:239], v[136:139], v[72:75]
  ds_read_b128 v[52:55], v2 offset:10240
  v_permlane16_swap_b32 v36, v38
  v_mfma_f32_16x16x32_bf16 v[76:79], a[232:235], v[132:135], 0
  buffer_load_dwordx4 v2, s[12:15], s60 offen offset:3072 sc1 lds
  v_mfma_f32_16x16x32_bf16 v[76:79], a[236:239], v[140:143], v[76:79]
  s_waitcnt lgkmcnt(4)
  v_permlane16_swap_b32 v37, v39
  v_fmac_f32 v112, v16, v4
  v_fmac_f32 v113, v17, v4
  v_mfma_f32_16x16x32_bf16 v[64:67], a[240:243], v[144:147], v[64:67]
  s_add_u32 m0, s51, 102400
  ds_read_b128 v[56:59], v2 offset:9216
  v_fmac_f32 v114, v18, v4
  v_mfma_f32_16x16x32_bf16 v[64:67], a[244:247], v[152:155], v[64:67]
  s_add_u32 s60, s50, 200704
  ds_read_b128 v[60:63], v2 offset:11264
  v_fmac_f32 v115, v19, v4
  v_mfma_f32_16x16x32_bf16 v[68:71], a[240:243], v[148:151], v[68:71]
  buffer_store_dwordx4 v[36:39], v7, s[12:15], s64 offen offset:2048 sc1
  v_mfma_f32_16x16x32_bf16 v[68:71], a[244:247], v[156:159], v[68:71]
  s_waitcnt lgkmcnt(4)
  buffer_load_dwordx4 v2, s[12:15], s60 offen offset:0 sc1 lds
  v_fmac_f32 v116, v16, v24
  v_mfma_f32_16x16x32_bf16 v[72:75], a[248:251], v[144:147], v[72:75]
  ds_read_b128 a[224:227], v2 offset:12288
  v_fmac_f32 v117, v17, v24
  v_mfma_f32_16x16x32_bf16 v[72:75], a[252:255], v[152:155], v[72:75]
  ds_read_b128 a[228:231], v2 offset:14336
  v_fmac_f32 v118, v18, v24
  v_mfma_f32_16x16x32_bf16 v[76:79], a[248:251], v[148:151], v[76:79]
  v_fmac_f32 v119, v19, v24
  v_mul_f32 v112, v112, v5
  v_mfma_f32_16x16x32_bf16 v[76:79], a[252:255], v[156:159], v[76:79]
  s_waitcnt lgkmcnt(4)
  ds_read_b128 v[16:19], v8 offset:512
  v_exp_f32 v112, v112
  v_mfma_f32_16x16x32_bf16 v[64:67], v[48:51], v[160:163], v[64:67]
  ds_read_b128 a[232:235], v2 offset:13312
  buffer_load_dwordx4 v2, s[12:15], s60 offen offset:1024 sc1 lds
  v_mfma_f32_16x16x32_bf16 v[64:67], v[52:55], v[168:171], v[64:67]
  ds_read_b128 a[236:239], v2 offset:15360
  v_mul_f32 v113, v113, v5
  v_mfma_f32_16x16x32_bf16 v[68:71], v[48:51], v[164:167], v[68:71]
  v_exp_f32 v113, v113
  v_mfma_f32_16x16x32_bf16 v[68:71], v[52:55], v[172:175], v[68:71]
  s_waitcnt lgkmcnt(5)
  v_mul_f32 v114, v114, v5
  v_exp_f32 v114, v114
  v_mfma_f32_16x16x32_bf16 v[72:75], v[56:59], v[160:163], v[72:75]
  ds_read_b128 a[240:243], v2 offset:16384
  buffer_load_dwordx4 v2, s[12:15], s60 offen offset:2048 sc1 lds
  v_mfma_f32_16x16x32_bf16 v[72:75], v[60:63], v[168:171], v[72:75]
  ds_read_b128 a[244:247], v2 offset:18432
  v_mul_f32 v115, v115, v5
  v_mfma_f32_16x16x32_bf16 v[76:79], v[56:59], v[164:167], v[76:79]
  v_exp_f32 v115, v115
  v_mfma_f32_16x16x32_bf16 v[76:79], v[60:63], v[172:175], v[76:79]
  s_waitcnt lgkmcnt(5)
  v_mul_f32 v116, v116, v25
  v_exp_f32 v116, v116
  v_mfma_f32_16x16x32_bf16 v[64:67], a[224:227], v[176:179], v[64:67]
  ds_read_b128 a[248:251], v2 offset:17408
  v_mul_f32 v117, v117, v25
  v_mfma_f32_16x16x32_bf16 v[64:67], a[228:231], v[184:187], v[64:67]
  ds_read_b128 a[252:255], v2 offset:19456
  buffer_load_dwordx4 v2, s[12:15], s60 offen offset:3072 sc1 lds
  v_mfma_f32_16x16x32_bf16 v[68:71], a[224:227], v[180:183], v[68:71]
  v_exp_f32 v117, v117
  v_mfma_f32_16x16x32_bf16 v[68:71], a[228:231], v[188:191], v[68:71]
  s_waitcnt lgkmcnt(4)
  v_mul_f32 v118, v118, v25
  v_exp_f32 v118, v118
  v_mfma_f32_16x16x32_bf16 v[72:75], a[232:235], v[176:179], v[72:75]
  ds_read_b128 v[48:51], v2 offset:20480
  v_mul_f32 v119, v119, v25
  v_mfma_f32_16x16x32_bf16 v[72:75], a[236:239], v[184:187], v[72:75]
  ds_read_b128 v[52:55], v2 offset:22528
  v_fmac_f32 v120, v20, v4
  v_mfma_f32_16x16x32_bf16 v[76:79], a[232:235], v[180:183], v[76:79]
  buffer_load_dwordx4 a[112:115], v2, s[12:15], s57 offen offset:0 sc1
  v_mfma_f32_16x16x32_bf16 v[76:79], a[236:239], v[188:191], v[76:79]
  s_waitcnt lgkmcnt(4)
  v_exp_f32 v119, v119
  v_fmac_f32 v121, v21, v4
  v_mfma_f32_16x16x32_bf16 v[64:67], a[240:243], v[192:195], v[64:67]
  ds_read_b128 v[56:59], v2 offset:21504
  v_fmac_f32 v122, v22, v4
  v_mfma_f32_16x16x32_bf16 v[64:67], a[244:247], v[200:203], v[64:67]
  ds_read_b128 v[60:63], v2 offset:23552
  v_fmac_f32 v123, v23, v4
  v_mfma_f32_16x16x32_bf16 v[68:71], a[240:243], v[196:199], v[68:71]
  v_fmac_f32 v124, v20, v24
  v_fmac_f32 v125, v21, v24
  v_mfma_f32_16x16x32_bf16 v[68:71], a[244:247], v[204:207], v[68:71]
  s_waitcnt lgkmcnt(4)
  buffer_load_dwordx4 a[116:119], v2, s[12:15], s57 offen offset:1024 sc1
  v_fmac_f32 v126, v22, v24
  v_mfma_f32_16x16x32_bf16 v[72:75], a[248:251], v[192:195], v[72:75]
  ds_read_b128 a[224:227], v2 offset:24576
  v_fmac_f32 v127, v23, v24
  v_mfma_f32_16x16x32_bf16 v[72:75], a[252:255], v[200:203], v[72:75]
  ds_read_b128 a[228:231], v2 offset:26624
  ds_read_b128 v[20:23], v8 offset:576
  v_mfma_f32_16x16x32_bf16 v[76:79], a[248:251], v[196:199], v[76:79]
  v_fma_f32 v112, v112, v6, v6
  v_fma_f32 v113, v113, v6, v6
  v_mfma_f32_16x16x32_bf16 v[76:79], a[252:255], v[204:207], v[76:79]
  s_waitcnt lgkmcnt(5)
  buffer_load_dwordx4 a[120:123], v2, s[12:15], s57 offen offset:2048 sc1
  v_fma_f32 v114, v114, v6, v6
  v_mfma_f32_16x16x32_bf16 v[64:67], v[48:51], v[208:211], v[64:67]
  ds_read_b128 a[232:235], v2 offset:25600
  v_fma_f32 v115, v115, v6, v6
  v_mfma_f32_16x16x32_bf16 v[64:67], v[52:55], v[216:219], v[64:67]
  ds_read_b128 a[236:239], v2 offset:27648
  v_fma_f32 v116, v116, v26, v26
  v_mfma_f32_16x16x32_bf16 v[68:71], v[48:51], v[212:215], v[68:71]
  v_rcp_f32 v112, v112
  v_mfma_f32_16x16x32_bf16 v[68:71], v[52:55], v[220:223], v[68:71]
  s_waitcnt lgkmcnt(5)
  v_rcp_f32 v113, v113
  v_fma_f32 v117, v117, v26, v26
  v_mfma_f32_16x16x32_bf16 v[72:75], v[56:59], v[208:211], v[72:75]
  ds_read_b128 a[240:243], v2 offset:28672
  buffer_load_dwordx4 a[124:127], v2, s[12:15], s57 offen offset:3072 sc1
  v_mfma_f32_16x16x32_bf16 v[72:75], v[60:63], v[216:219], v[72:75]
  s_add_u32 s57, s49, 32768
  ds_read_b128 a[244:247], v2 offset:30720
  v_fma_f32 v118, v118, v26, v26
  v_mfma_f32_16x16x32_bf16 v[76:79], v[56:59], v[212:215], v[76:79]
  v_rcp_f32 v114, v114
  v_mfma_f32_16x16x32_bf16 v[76:79], v[60:63], v[220:223], v[76:79]
  s_waitcnt lgkmcnt(5)
  v_rcp_f32 v115, v115
  v_fma_f32 v119, v119, v26, v26
  v_mfma_f32_16x16x32_bf16 v[64:67], a[224:227], v[224:227], v[64:67]
  ds_read_b128 a[248:251], v2 offset:29696
  v_mul_f32 v120, v120, v112
  v_mfma_f32_16x16x32_bf16 v[64:67], a[228:231], v[232:235], v[64:67]
  ds_read_b128 a[252:255], v2 offset:31744
  buffer_load_dwordx4 a[128:131], v2, s[12:15], s57 offen offset:0 sc1
  v_mfma_f32_16x16x32_bf16 v[68:71], a[224:227], v[228:231], v[68:71]
  v_rcp_f32 v116, v116
  v_mfma_f32_16x16x32_bf16 v[68:71], a[228:231], v[236:239], v[68:71]
  s_waitcnt lgkmcnt(4)
  v_rcp_f32 v117, v117
  v_mul_f32 v121, v121, v113
  v_mfma_f32_16x16x32_bf16 v[72:75], a[232:235], v[224:227], v[72:75]
  s_waitcnt vmcnt(15)
  s_barrier
  ds_read_b128 a[224:227], v2 offset:32768
  v_mfma_f32_16x16x32_bf16 v[72:75], a[236:239], v[232:235], v[72:75]
  ds_read_b128 a[228:231], v2 offset:34816
  v_mul_f32 v122, v122, v114
  v_mfma_f32_16x16x32_bf16 v[76:79], a[232:235], v[228:231], v[76:79]
  buffer_load_dwordx4 a[132:135], v2, s[12:15], s57 offen offset:1024 sc1
  v_mfma_f32_16x16x32_bf16 v[76:79], a[236:239], v[236:239], v[76:79]
  s_waitcnt lgkmcnt(4)
  v_rcp_f32 v118, v118
  v_mul_f32 v123, v123, v115
  v_mfma_f32_16x16x32_bf16 v[64:67], a[240:243], v[240:243], v[64:67]
  ds_read_b128 a[232:235], v2 offset:33792
  v_mul_f32 v124, v124, v116
  v_mfma_f32_16x16x32_bf16 v[64:67], a[244:247], v[248:251], v[64:67]
  ds_read_b128 a[236:239], v2 offset:35840
  v_mul_f32 v125, v125, v117
  v_mfma_f32_16x16x32_bf16 v[68:71], a[240:243], v[244:247], v[68:71]
  v_rcp_f32 v119, v119
  v_mfma_f32_16x16x32_bf16 v[68:71], a[244:247], v[252:255], v[68:71]
  s_waitcnt lgkmcnt(4)
  buffer_load_dwordx4 a[136:139], v2, s[12:15], s57 offen offset:2048 sc1
  v_mul_f32 v126, v126, v118
  v_mfma_f32_16x16x32_bf16 v[72:75], a[248:251], v[240:243], v[72:75]
  ds_read_b128 a[240:243], v2 offset:36864
  v_cvt_pk_bf16_f32 v36, v120, v121
  v_mfma_f32_16x16x32_bf16 v[72:75], a[252:255], v[248:251], v[72:75]
  ds_read_b128 a[244:247], v2 offset:38912
  v_mul_f32 v127, v127, v119
  v_mfma_f32_16x16x32_bf16 v[76:79], a[248:251], v[244:247], v[76:79]
  v_cvt_pk_bf16_f32 v38, v124, v125
  v_cvt_pk_bf16_f32 v37, v122, v123
  v_mfma_f32_16x16x32_bf16 v[76:79], a[252:255], v[252:255], v[76:79]
  s_waitcnt lgkmcnt(4)
  buffer_load_dwordx4 a[140:143], v2, s[12:15], s57 offen offset:3072 sc1
  v_cvt_pk_bf16_f32 v39, v126, v127
  v_mfma_f32_16x16x32_bf16 v[80:83], a[224:227], v[128:131], 0
  s_add_u32 s57, s49, 36864
  ds_read_b128 a[248:251], v2 offset:37888
  v_permlane16_swap_b32 v36, v38
  v_mfma_f32_16x16x32_bf16 v[80:83], a[228:231], v[136:139], v[80:83]
  ds_read_b128 a[252:255], v2 offset:39936
  v_permlane16_swap_b32 v37, v39
  v_mfma_f32_16x16x32_bf16 v[84:87], a[224:227], v[132:135], 0
  buffer_store_dwordx4 v[36:39], v7, s[12:15], s64 offen offset:3072 sc1
  v_mfma_f32_16x16x32_bf16 v[84:87], a[228:231], v[140:143], v[84:87]
  s_waitcnt lgkmcnt(4)
  v_mfma_f32_16x16x32_bf16 v[88:91], a[232:235], v[128:131], 0
  ds_read_b128 a[224:227], v2 offset:40960
  buffer_load_dwordx4 a[144:147], v2, s[12:15], s57 offen offset:0 sc1
  v_mfma_f32_16x16x32_bf16 v[88:91], a[236:239], v[136:139], v[88:91]
  ds_read_b128 a[228:231], v2 offset:43008
  v_fmac_f32 v64, v16, v4
  v_mfma_f32_16x16x32_bf16 v[92:95], a[232:235], v[132:135], 0
  v_fmac_f32 v65, v17, v4
  v_fmac_f32 v66, v18, v4
  v_mfma_f32_16x16x32_bf16 v[92:95], a[236:239], v[140:143], v[92:95]
  s_waitcnt lgkmcnt(4)
  v_fmac_f32 v67, v19, v4
  v_fmac_f32 v68, v16, v24
  v_fmac_f32 v69, v17, v24
  v_mfma_f32_16x16x32_bf16 v[80:83], a[240:243], v[144:147], v[80:83]
  ds_read_b128 a[232:235], v2 offset:41984
  v_fmac_f32 v70, v18, v24
  v_mfma_f32_16x16x32_bf16 v[80:83], a[244:247], v[152:155], v[80:83]
  ds_read_b128 a[236:239], v2 offset:44032
  buffer_load_dwordx4 a[148:151], v2, s[12:15], s57 offen offset:1024 sc1
  v_mfma_f32_16x16x32_bf16 v[84:87], a[240:243], v[148:151], v[84:87]
  v_fmac_f32 v71, v19, v24
  v_mul_f32 v64, v64, v5
  v_mfma_f32_16x16x32_bf16 v[84:87], a[244:247], v[156:159], v[84:87]
  s_waitcnt lgkmcnt(4)
  ds_read_b128 v[16:19], v8 offset:640
  v_exp_f32 v64, v64
  v_mfma_f32_16x16x32_bf16 v[88:91], a[248:251], v[144:147], v[88:91]
  ds_read_b128 a[240:243], v2 offset:45056
  v_mul_f32 v65, v65, v5
  v_mfma_f32_16x16x32_bf16 v[88:91], a[252:255], v[152:155], v[88:91]
  ds_read_b128 a[244:247], v2 offset:47104
  v_mul_f32 v66, v66, v5
  v_mfma_f32_16x16x32_bf16 v[92:95], a[248:251], v[148:151], v[92:95]
  buffer_load_dwordx4 a[152:155], v2, s[12:15], s57 offen offset:2048 sc1
  v_mfma_f32_16x16x32_bf16 v[92:95], a[252:255], v[156:159], v[92:95]
  s_waitcnt lgkmcnt(5)
  v_exp_f32 v65, v65
  v_mul_f32 v67, v67, v5
  v_mfma_f32_16x16x32_bf16 v[80:83], a[224:227], v[160:163], v[80:83]
  ds_read_b128 a[248:251], v2 offset:46080
  v_mul_f32 v68, v68, v25
  v_mfma_f32_16x16x32_bf16 v[80:83], a[228:231], v[168:171], v[80:83]
  ds_read_b128 a[252:255], v2 offset:48128
  v_mul_f32 v69, v69, v25
  v_mfma_f32_16x16x32_bf16 v[84:87], a[224:227], v[164:167], v[84:87]
  buffer_load_dwordx4 a[156:159], v2, s[12:15], s57 offen offset:3072 sc1
  v_mfma_f32_16x16x32_bf16 v[84:87], a[228:231], v[172:175], v[84:87]
  s_waitcnt lgkmcnt(5)
  v_exp_f32 v66, v66
  v_mul_f32 v70, v70, v25
  v_mfma_f32_16x16x32_bf16 v[88:91], a[232:235], v[160:163], v[88:91]
  s_add_u32 s57, s49, 40960
  ds_read_b128 a[224:227], v2 offset:49152
  v_mul_f32 v71, v71, v25
  v_mfma_f32_16x16x32_bf16 v[88:91], a[236:239], v[168:171], v[88:91]
  ds_read_b128 a[228:231], v2 offset:51200
  v_fmac_f32 v72, v20, v4
  v_mfma_f32_16x16x32_bf16 v[92:95], a[232:235], v[164:167], v[92:95]
  v_exp_f32 v67, v67
  v_mfma_f32_16x16x32_bf16 v[92:95], a[236:239], v[172:175], v[92:95]
  s_waitcnt lgkmcnt(4)
  buffer_load_dwordx4 a[160:163], v2, s[12:15], s57 offen offset:0 sc1
  v_fmac_f32 v73, v21, v4
  v_mfma_f32_16x16x32_bf16 v[80:83], a[240:243], v[176:179], v[80:83]
  ds_read_b128 a[232:235], v2 offset:50176
  v_fmac_f32 v74, v22, v4
  v_mfma_f32_16x16x32_bf16 v[80:83], a[244:247], v[184:187], v[80:83]
  ds_read_b128 a[236:239], v2 offset:52224
  v_fmac_f32 v75, v23, v4
  v_mfma_f32_16x16x32_bf16 v[84:87], a[240:243], v[180:183], v[84:87]
  v_exp_f32 v68, v68
  v_mfma_f32_16x16x32_bf16 v[84:87], a[244:247], v[188:191], v[84:87]
  s_waitcnt lgkmcnt(4)
  v_exp_f32 v69, v69
  v_fmac_f32 v76, v20, v24
  v_mfma_f32_16x16x32_bf16 v[88:91], a[248:251], v[176:179], v[88:91]
  ds_read_b128 a[240:243], v2 offset:53248
  buffer_load_dwordx4 a[164:167], v2, s[12:15], s57 offen offset:1024 sc1
  v_mfma_f32_16x16x32_bf16 v[88:91], a[252:255], v[184:187], v[88:91]
  ds_read_b128 a[244:247], v2 offset:55296
  v_fmac_f32 v77, v21, v24
  v_mfma_f32_16x16x32_bf16 v[92:95], a[248:251], v[180:183], v[92:95]
  v_exp_f32 v70, v70
  v_mfma_f32_16x16x32_bf16 v[92:95], a[252:255], v[188:191], v[92:95]
  s_waitcnt lgkmcnt(4)
  v_exp_f32 v71, v71
  v_fmac_f32 v78, v22, v24
  v_mfma_f32_16x16x32_bf16 v[80:83], a[224:227], v[192:195], v[80:83]
  ds_read_b128 a[248:251], v2 offset:54272
  s_waitcnt vmcnt(6)
  buffer_atomic_add v34, v33, s[12:15], s66 offen sc1
  v_mfma_f32_16x16x32_bf16 v[80:83], a[228:231], v[200:203], v[80:83]
  ds_read_b128 a[252:255], v2 offset:56320
  buffer_load_dwordx4 a[168:171], v2, s[12:15], s57 offen offset:2048 sc1
  v_mfma_f32_16x16x32_bf16 v[84:87], a[224:227], v[196:199], v[84:87]
  v_fmac_f32 v79, v23, v24
  v_fma_f32 v64, v64, v6, v6
  v_mfma_f32_16x16x32_bf16 v[84:87], a[228:231], v[204:207], v[84:87]
  s_waitcnt lgkmcnt(4)
  ds_read_b128 v[20:23], v8 offset:704
  v_rcp_f32 v64, v64
  v_mfma_f32_16x16x32_bf16 v[88:91], a[232:235], v[192:195], v[88:91]
  ds_read_b128 a[224:227], v2 offset:57344
  v_fma_f32 v65, v65, v6, v6
  v_mfma_f32_16x16x32_bf16 v[88:91], a[236:239], v[200:203], v[88:91]
  ds_read_b128 a[228:231], v2 offset:59392
  buffer_load_dwordx4 a[172:175], v2, s[12:15], s57 offen offset:3072 sc1
  v_mfma_f32_16x16x32_bf16 v[92:95], a[232:235], v[196:199], v[92:95]
  s_add_u32 s57, s49, 45056
  v_rcp_f32 v65, v65
  v_mfma_f32_16x16x32_bf16 v[92:95], a[236:239], v[204:207], v[92:95]
  s_waitcnt lgkmcnt(5)
  v_fma_f32 v66, v66, v6, v6
  v_rcp_f32 v66, v66
  v_mfma_f32_16x16x32_bf16 v[80:83], a[240:243], v[208:211], v[80:83]
  ds_read_b128 a[232:235], v2 offset:58368
  v_fma_f32 v67, v67, v6, v6
  v_mfma_f32_16x16x32_bf16 v[80:83], a[244:247], v[216:219], v[80:83]
  ds_read_b128 a[236:239], v2 offset:60416
  v_fma_f32 v68, v68, v26, v26
  v_mfma_f32_16x16x32_bf16 v[84:87], a[240:243], v[212:215], v[84:87]
  buffer_load_dwordx4 a[176:179], v2, s[12:15], s57 offen offset:0 sc1
  v_mfma_f32_16x16x32_bf16 v[84:87], a[244:247], v[220:223], v[84:87]
  s_waitcnt lgkmcnt(5)
  v_rcp_f32 v67, v67
  v_fma_f32 v69, v69, v26, v26
  v_mfma_f32_16x16x32_bf16 v[88:91], a[248:251], v[208:211], v[88:91]
  ds_read_b128 a[240:243], v2 offset:61440
  v_fma_f32 v70, v70, v26, v26
  v_mfma_f32_16x16x32_bf16 v[88:91], a[252:255], v[216:219], v[88:91]
  ds_read_b128 a[244:247], v2 offset:63488
  v_fma_f32 v71, v71, v26, v26
  v_mfma_f32_16x16x32_bf16 v[92:95], a[248:251], v[212:215], v[92:95]
  v_rcp_f32 v68, v68
  v_mfma_f32_16x16x32_bf16 v[92:95], a[252:255], v[220:223], v[92:95]
  s_waitcnt lgkmcnt(4)
  buffer_load_dwordx4 a[180:183], v2, s[12:15], s57 offen offset:1024 sc1
  v_mul_f32 v72, v72, v64
  v_mfma_f32_16x16x32_bf16 v[80:83], a[224:227], v[224:227], v[80:83]
  ds_read_b128 a[248:251], v2 offset:62464
  v_mul_f32 v73, v73, v65
  v_mfma_f32_16x16x32_bf16 v[80:83], a[228:231], v[232:235], v[80:83]
  ds_read_b128 a[252:255], v2 offset:64512
  v_mul_f32 v74, v74, v66
  v_mfma_f32_16x16x32_bf16 v[84:87], a[224:227], v[228:231], v[84:87]
  v_rcp_f32 v69, v69
  v_mfma_f32_16x16x32_bf16 v[84:87], a[228:231], v[236:239], v[84:87]
  s_waitcnt lgkmcnt(4)
  v_rcp_f32 v70, v70
  v_mul_f32 v75, v75, v67
  v_mfma_f32_16x16x32_bf16 v[88:91], a[232:235], v[224:227], v[88:91]
  s_barrier
  ds_read_b128 a[224:227], v12 offset:0
  v_mfma_f32_16x16x32_bf16 v[88:91], a[236:239], v[232:235], v[88:91]
  ds_read_b128 a[228:231], v12 offset:2048
  buffer_load_dwordx4 a[184:187], v2, s[12:15], s57 offen offset:2048 sc1
  v_mfma_f32_16x16x32_bf16 v[92:95], a[232:235], v[228:231], v[92:95]
  v_rcp_f32 v71, v71
  v_mfma_f32_16x16x32_bf16 v[92:95], a[236:239], v[236:239], v[92:95]
  s_waitcnt lgkmcnt(4)
  v_mul_f32 v76, v76, v68
  v_mul_f32 v77, v77, v69
  v_mul_f32 v78, v78, v70
  v_mfma_f32_16x16x32_bf16 v[80:83], a[240:243], v[240:243], v[80:83]
  ds_read_b128 a[232:235], v12 offset:1024
  v_mov_b32 v9, 0
  buffer_atomic_add v9, v33, s[12:15], s67 offen sc0 sc1
  v_mfma_f32_16x16x32_bf16 v[80:83], a[244:247], v[248:251], v[80:83]
  ds_read_b128 a[236:239], v12 offset:3072
  buffer_load_dwordx4 a[188:191], v2, s[12:15], s57 offen offset:3072 sc1
  v_mfma_f32_16x16x32_bf16 v[84:87], a[240:243], v[244:247], v[84:87]
  s_add_u32 s57, s49, 49152
  v_cvt_pk_bf16_f32 v36, v72, v73
  v_mul_f32 v79, v79, v71
  v_mfma_f32_16x16x32_bf16 v[84:87], a[244:247], v[252:255], v[84:87]
  s_waitcnt lgkmcnt(4)
  v_cvt_pk_bf16_f32 v38, v76, v77
  v_cvt_pk_bf16_f32 v37, v74, v75
  v_cvt_pk_bf16_f32 v39, v78, v79
  v_mfma_f32_16x16x32_bf16 v[88:91], a[248:251], v[240:243], v[88:91]
  ds_read_b128 a[240:243], v12 offset:4096
  v_permlane16_swap_b32 v36, v38
  v_mfma_f32_16x16x32_bf16 v[88:91], a[252:255], v[248:251], v[88:91]
  ds_read_b128 a[244:247], v12 offset:6144
  buffer_load_dwordx4 a[192:195], v2, s[12:15], s57 offen offset:0 sc1
  v_mfma_f32_16x16x32_bf16 v[92:95], a[248:251], v[244:247], v[92:95]
  v_permlane16_swap_b32 v37, v39
  v_mfma_f32_16x16x32_bf16 v[92:95], a[252:255], v[252:255], v[92:95]
  s_waitcnt lgkmcnt(4)
  buffer_store_dwordx4 v[36:39], v7, s[12:15], s65 offen offset:0 sc1
  v_mfma_f32_16x16x32_bf16 v[48:51], a[224:227], v[128:131], 0
  ds_read_b128 a[248:251], v12 offset:5120
  v_mfma_f32_16x16x32_bf16 v[48:51], a[228:231], v[136:139], v[48:51]
  ds_read_b128 a[252:255], v12 offset:7168
  v_mfma_f32_16x16x32_bf16 v[52:55], a[224:227], v[132:135], 0
  buffer_load_dwordx4 a[196:199], v2, s[12:15], s57 offen offset:1024 sc1
  v_mfma_f32_16x16x32_bf16 v[52:55], a[228:231], v[140:143], v[52:55]
  s_waitcnt lgkmcnt(4)
  v_mfma_f32_16x16x32_bf16 v[56:59], a[232:235], v[128:131], 0
  ds_read_b128 a[224:227], v12 offset:8192
  v_fmac_f32 v80, v16, v4
  v_mfma_f32_16x16x32_bf16 v[56:59], a[236:239], v[136:139], v[56:59]
  ds_read_b128 a[228:231], v12 offset:10240
  v_fmac_f32 v81, v17, v4
  v_mfma_f32_16x16x32_bf16 v[60:63], a[232:235], v[132:135], 0
  v_fmac_f32 v82, v18, v4
  v_fmac_f32 v83, v19, v4
  v_mfma_f32_16x16x32_bf16 v[60:63], a[236:239], v[140:143], v[60:63]
  s_waitcnt lgkmcnt(4)
  buffer_load_dwordx4 a[200:203], v2, s[12:15], s57 offen offset:2048 sc1
  v_fmac_f32 v84, v16, v24
  v_mfma_f32_16x16x32_bf16 v[48:51], a[240:243], v[144:147], v[48:51]
  ds_read_b128 a[232:235], v12 offset:9216
  v_fmac_f32 v85, v17, v24
  v_mfma_f32_16x16x32_bf16 v[48:51], a[244:247], v[152:155], v[48:51]
  ds_read_b128 a[236:239], v12 offset:11264
  v_fmac_f32 v86, v18, v24
  v_mfma_f32_16x16x32_bf16 v[52:55], a[240:243], v[148:151], v[52:55]
  v_fmac_f32 v87, v19, v24
  v_mul_f32 v80, v80, v5
  v_mfma_f32_16x16x32_bf16 v[52:55], a[244:247], v[156:159], v[52:55]
  s_waitcnt lgkmcnt(4)
  ds_read_b128 v[16:19], v8 offset:768
  buffer_load_dwordx4 a[204:207], v2, s[12:15], s57 offen offset:3072 sc1
  v_mfma_f32_16x16x32_bf16 v[56:59], a[248:251], v[144:147], v[56:59]
  s_add_u32 s57, s49, 53248
  ds_read_b128 a[240:243], v12 offset:12288
  v_mul_f32 v81, v81, v5
  v_mfma_f32_16x16x32_bf16 v[56:59], a[252:255], v[152:155], v[56:59]
  ds_read_b128 a[244:247], v12 offset:14336
  v_mul_f32 v82, v82, v5
  v_mfma_f32_16x16x32_bf16 v[60:63], a[248:251], v[148:151], v[60:63]
  v_exp_f32 v80, v80
  v_mfma_f32_16x16x32_bf16 v[60:63], a[252:255], v[156:159], v[60:63]
  s_waitcnt lgkmcnt(5)
  v_exp_f32 v81, v81
  v_mul_f32 v83, v83, v5
  v_mfma_f32_16x16x32_bf16 v[48:51], a[224:227], v[160:163], v[48:51]
  ds_read_b128 a[248:251], v12 offset:13312
  buffer_load_dwordx4 a[208:211], v2, s[12:15], s57 offen offset:0 sc1
  v_mfma_f32_16x16x32_bf16 v[48:51], a[228:231], v[168:171], v[48:51]
  ds_read_b128 a[252:255], v12 offset:15360
  v_mul_f32 v84, v84, v25
  v_mfma_f32_16x16x32_bf16 v[52:55], a[224:227], v[164:167], v[52:55]
  v_exp_f32 v82, v82
  v_mfma_f32_16x16x32_bf16 v[52:55], a[228:231], v[172:175], v[52:55]
  s_waitcnt lgkmcnt(5)
  v_exp_f32 v83, v83
  v_mul_f32 v85, v85, v25
  v_mfma_f32_16x16x32_bf16 v[56:59], a[232:235], v[160:163], v[56:59]
  ds_read_b128 a[224:227], v12 offset:16384
  v_mul_f32 v86, v86, v25
  v_mfma_f32_16x16x32_bf16 v[56:59], a[236:239], v[168:171], v[56:59]
  ds_read_b128 a[228:231], v12 offset:18432
  buffer_load_dwordx4 a[212:215], v2, s[12:15], s57 offen offset:1024 sc1
  v_mfma_f32_16x16x32_bf16 v[60:63], a[232:235], v[164:167], v[60:63]
  v_exp_f32 v84, v84
  v_mfma_f32_16x16x32_bf16 v[60:63], a[236:239], v[172:175], v[60:63]
  s_waitcnt lgkmcnt(4)
  v_exp_f32 v85, v85
  v_mul_f32 v87, v87, v25
  s_waitcnt vmcnt(8)
  v_readfirstlane_b32 s99, v9
  s_nop 0
  s_bfe_u32 s99, s99, 0x80000
  s_cmp_lt_u32 s99, 8
  s_cbranch_scc1 L_spin8
L_back8:
  v_mfma_f32_16x16x32_bf16 v[48:51], a[240:243], v[176:179], v[48:51]
  ds_read_b128 a[232:235], v12 offset:17408
  v_fmac_f32 v88, v20, v4
  v_mfma_f32_16x16x32_bf16 v[48:51], a[244:247], v[184:187], v[48:51]
  ds_read_b128 a[236:239], v12 offset:19456
  v_fmac_f32 v89, v21, v4
  v_mfma_f32_16x16x32_bf16 v[52:55], a[240:243], v[180:183], v[52:55]
  buffer_load_dwordx4 a[216:219], v2, s[12:15], s57 offen offset:2048 sc1
  v_mfma_f32_16x16x32_bf16 v[52:55], a[244:247], v[188:191], v[52:55]
  s_waitcnt lgkmcnt(4)
  v_exp_f32 v86, v86
  v_fmac_f32 v90, v22, v4
  v_mfma_f32_16x16x32_bf16 v[56:59], a[248:251], v[176:179], v[56:59]
  ds_read_b128 a[240:243], v12 offset:20480
  v_fmac_f32 v91, v23, v4
  v_mfma_f32_16x16x32_bf16 v[56:59], a[252:255], v[184:187], v[56:59]
  ds_read_b128 a[244:247], v12 offset:22528
  v_fmac_f32 v92, v20, v24
  v_mfma_f32_16x16x32_bf16 v[60:63], a[248:251], v[180:183], v[60:63]
  v_exp_f32 v87, v87
  v_mfma_f32_16x16x32_bf16 v[60:63], a[252:255], v[188:191], v[60:63]
  s_waitcnt lgkmcnt(4)
  buffer_load_dwordx4 a[220:223], v2, s[12:15], s57 offen offset:3072 sc1
  v_fmac_f32 v93, v21, v24
  v_mfma_f32_16x16x32_bf16 v[48:51], a[224:227], v[192:195], v[48:51]
  ds_read_b128 a[248:251], v12 offset:21504
  v_fmac_f32 v94, v22, v24
  v_mfma_f32_16x16x32_bf16 v[48:51], a[228:231], v[200:203], v[48:51]
  ds_read_b128 a[252:255], v12 offset:23552
  v_fmac_f32 v95, v23, v24
  v_mfma_f32_16x16x32_bf16 v[52:55], a[224:227], v[196:199], v[52:55]
  ds_read_b128 v[20:23], v8 offset:832
  v_fma_f32 v80, v80, v6, v6
  v_mfma_f32_16x16x32_bf16 v[52:55], a[228:231], v[204:207], v[52:55]
  s_waitcnt lgkmcnt(5)
  buffer_load_dwordx4 v[128:131], v40, s[12:15], s68 offen offset:0 sc1
  v_fma_f32 v81, v81, v6, v6
  v_mfma_f32_16x16x32_bf16 v[56:59], a[232:235], v[192:195], v[56:59]
  ds_read_b128 a[224:227], v12 offset:24576
  v_fma_f32 v82, v82, v6, v6
  v_mfma_f32_16x16x32_bf16 v[56:59], a[236:239], v[200:203], v[56:59]
  ds_read_b128 a[228:231], v12 offset:26624
  v_fma_f32 v83, v83, v6, v6
  v_mfma_f32_16x16x32_bf16 v[60:63], a[232:235], v[196:199], v[60:63]
  v_rcp_f32 v80, v80
  v_mfma_f32_16x16x32_bf16 v[60:63], a[236:239], v[204:207], v[60:63]
  s_waitcnt lgkmcnt(5)
  buffer_load_dwordx4 v[132:135], v40, s[12:15], s70 offen offset:0 sc1
  v_fma_f32 v84, v84, v26, v26
  v_mfma_f32_16x16x32_bf16 v[48:51], a[240:243], v[208:211], v[48:51]
  ds_read_b128 a[232:235], v12 offset:25600
  v_fma_f32 v85, v85, v26, v26
  v_mfma_f32_16x16x32_bf16 v[48:51], a[244:247], v[216:219], v[48:51]
  ds_read_b128 a[236:239], v12 offset:27648
  v_fma_f32 v86, v86, v26, v26
  v_mfma_f32_16x16x32_bf16 v[52:55], a[240:243], v[212:215], v[52:55]
  v_rcp_f32 v81, v81
  v_mfma_f32_16x16x32_bf16 v[52:55], a[244:247], v[220:223], v[52:55]
  s_waitcnt lgkmcnt(5)
  buffer_load_dwordx4 v[136:139], v41, s[12:15], s68 offen offset:0 sc1
  v_fma_f32 v87, v87, v26, v26
  v_mfma_f32_16x16x32_bf16 v[56:59], a[248:251], v[208:211], v[56:59]
  ds_read_b128 a[240:243], v12 offset:28672
  v_mul_f32 v88, v88, v80
  v_mfma_f32_16x16x32_bf16 v[56:59], a[252:255], v[216:219], v[56:59]
  ds_read_b128 a[244:247], v12 offset:30720
  v_mul_f32 v89, v89, v81
  v_mfma_f32_16x16x32_bf16 v[60:63], a[248:251], v[212:215], v[60:63]
  v_rcp_f32 v82, v82
  v_mfma_f32_16x16x32_bf16 v[60:63], a[252:255], v[220:223], v[60:63]
  s_waitcnt lgkmcnt(4)
  buffer_load_dwordx4 v[140:143], v41, s[12:15], s70 offen offset:0 sc1
  v_mul_f32 v90, v90, v82
  v_mfma_f32_16x16x32_bf16 v[48:51], a[224:227], v[224:227], v[48:51]
  ds_read_b128 a[248:251], v12 offset:29696
  v_cvt_pk_bf16_f32 v36, v88, v89
  v_mfma_f32_16x16x32_bf16 v[48:51], a[228:231], v[232:235], v[48:51]
  ds_read_b128 a[252:255], v12 offset:31744
  v_mfma_f32_16x16x32_bf16 v[52:55], a[224:227], v[228:231], v[52:55]
  v_rcp_f32 v83, v83
  v_mfma_f32_16x16x32_bf16 v[52:55], a[228:231], v[236:239], v[52:55]
  s_waitcnt lgkmcnt(4)
  buffer_load_dwordx4 v[144:147], v42, s[12:15], s68 offen offset:0 sc1
  v_mul_f32 v91, v91, v83
  v_mfma_f32_16x16x32_bf16 v[56:59], a[232:235], v[224:227], v[56:59]
  v_rcp_f32 v84, v84
  v_mfma_f32_16x16x32_bf16 v[56:59], a[236:239], v[232:235], v[56:59]
  v_rcp_f32 v85, v85
  v_mfma_f32_16x16x32_bf16 v[60:63], a[232:235], v[228:231], v[60:63]
  v_rcp_f32 v86, v86
  v_mfma_f32_16x16x32_bf16 v[60:63], a[236:239], v[236:239], v[60:63]
  s_waitcnt lgkmcnt(2)
  buffer_load_dwordx4 v[148:151], v42, s[12:15], s70 offen offset:0 sc1
  v_mul_f32 v92, v92, v84
  v_mfma_f32_16x16x32_bf16 v[48:51], a[240:243], v[240:243], v[48:51]
  v_rcp_f32 v87, v87
  v_mfma_f32_16x16x32_bf16 v[48:51], a[244:247], v[248:251], v[48:51]
  v_mul_f32 v93, v93, v85
  v_mul_f32 v94, v94, v86
  v_mfma_f32_16x16x32_bf16 v[52:55], a[240:243], v[244:247], v[52:55]
  v_mul_f32 v95, v95, v87
  v_cvt_pk_bf16_f32 v38, v92, v93
  v_mfma_f32_16x16x32_bf16 v[52:55], a[244:247], v[252:255], v[52:55]
  s_waitcnt lgkmcnt(0)
  buffer_load_dwordx4 v[152:155], v43, s[12:15], s68 offen offset:0 sc1
  v_cvt_pk_bf16_f32 v37, v90, v91
  v_mfma_f32_16x16x32_bf16 v[56:59], a[248:251], v[240:243], v[56:59]
  v_cvt_pk_bf16_f32 v39, v94, v95
  v_permlane16_swap_b32 v36, v38
  v_mfma_f32_16x16x32_bf16 v[56:59], a[252:255], v[248:251], v[56:59]
  v_permlane16_swap_b32 v37, v39
  v_mfma_f32_16x16x32_bf16 v[60:63], a[248:251], v[244:247], v[60:63]
  buffer_store_dwordx4 v[36:39], v7, s[12:15], s65 offen offset:1024 sc1
  v_mfma_f32_16x16x32_bf16 v[60:63], a[252:255], v[252:255], v[60:63]
  buffer_load_dwordx4 v[156:159], v43, s[12:15], s70 offen offset:0 sc1
  buffer_load_dwordx4 v[160:163], v40, s[12:15], s68 offen offset:1024 sc1
  buffer_load_dwordx4 v[164:167], v40, s[12:15], s70 offen offset:1024 sc1
  s_waitcnt vmcnt(10)
  v_mfma_f32_16x16x32_bf16 v[64:67], a[0:3], v[128:131], 0
  v_fmac_f32 v48, v16, v4
  v_fmac_f32 v49, v17, v4
  v_fmac_f32 v50, v18, v4
  v_fmac_f32 v51, v19, v4
  v_fmac_f32 v52, v16, v24
  v_fmac_f32 v53, v17, v24
  s_waitcnt vmcnt(9)
  v_mfma_f32_16x16x32_bf16 v[64:67], a[112:115], v[132:135], v[64:67]
  v_fmac_f32 v54, v18, v24
  v_fmac_f32 v55, v19, v24
  v_mul_f32 v48, v48, v5
  v_mul_f32 v49, v49, v5
  v_mul_f32 v50, v50, v5
  v_mul_f32 v51, v51, v5
  v_mfma_f32_16x16x32_bf16 v[68:71], a[4:7], v[128:131], 0
  v_mul_f32 v52, v52, v25
  v_mul_f32 v53, v53, v25
  v_mul_f32 v54, v54, v25
  v_mul_f32 v55, v55, v25
  v_exp_f32 v48, v48
  v_mfma_f32_16x16x32_bf16 v[68:71], a[116:119], v[132:135], v[68:71]
  buffer_load_dwordx4 v[168:171], v41, s[12:15], s68 offen offset:1024 sc1
  v_fmac_f32 v56, v20, v4
  v_exp_f32 v49, v49
  v_fmac_f32 v57, v21, v4
  v_mfma_f32_16x16x32_bf16 v[72:75], a[8:11], v[128:131], 0
  v_exp_f32 v50, v50
  v_fmac_f32 v58, v22, v4
  v_exp_f32 v51, v51
  v_fmac_f32 v59, v23, v4
  v_mfma_f32_16x16x32_bf16 v[72:75], a[120:123], v[132:135], v[72:75]
  v_exp_f32 v52, v52
  v_fmac_f32 v60, v20, v24
  v_exp_f32 v53, v53
  v_fmac_f32 v61, v21, v24
  v_mfma_f32_16x16x32_bf16 v[76:79], a[12:15], v[128:131], 0
  v_exp_f32 v54, v54
  v_fmac_f32 v62, v22, v24
  v_exp_f32 v55, v55
  v_fmac_f32 v63, v23, v24
  v_mfma_f32_16x16x32_bf16 v[76:79], a[124:127], v[132:135], v[76:79]
  s_waitcnt vmcnt(8)
  buffer_load_dwordx4 v[172:175], v41, s[12:15], s70 offen offset:1024 sc1
  v_fma_f32 v48, v48, v6, v6
  v_fma_f32 v49, v49, v6, v6
  v_fma_f32 v50, v50, v6, v6
  v_fma_f32 v51, v51, v6, v6
  v_fma_f32 v52, v52, v26, v26
  v_mfma_f32_16x16x32_bf16 v[80:83], a[0:3], v[136:139], 0
  v_fma_f32 v53, v53, v26, v26
  v_fma_f32 v54, v54, v26, v26
  v_fma_f32 v55, v55, v26, v26
  v_rcp_f32 v48, v48
  v_mfma_f32_16x16x32_bf16 v[80:83], a[112:115], v[140:143], v[80:83]
  v_rcp_f32 v49, v49
  v_mul_f32 v56, v56, v48
  v_rcp_f32 v50, v50
  v_mul_f32 v57, v57, v49
  v_mfma_f32_16x16x32_bf16 v[84:87], a[4:7], v[136:139], 0
  v_rcp_f32 v51, v51
  v_mul_f32 v58, v58, v50
  v_rcp_f32 v52, v52
  v_mul_f32 v59, v59, v51
  v_mfma_f32_16x16x32_bf16 v[84:87], a[116:119], v[140:143], v[84:87]
  buffer_load_dwordx4 v[176:179], v42, s[12:15], s68 offen offset:1024 sc1
  v_rcp_f32 v53, v53
  v_mul_f32 v60, v60, v52
  v_rcp_f32 v54, v54
  v_mfma_f32_16x16x32_bf16 v[88:91], a[8:11], v[136:139], 0
  v_mul_f32 v61, v61, v53
  v_rcp_f32 v55, v55
  v_mul_f32 v62, v62, v54
  v_cvt_pk_bf16_f32 v36, v56, v57
  v_mul_f32 v63, v63, v55
  v_mfma_f32_16x16x32_bf16 v[88:91], a[120:123], v[140:143], v[88:91]
  v_cvt_pk_bf16_f32 v38, v60, v61
  v_cvt_pk_bf16_f32 v37, v58, v59
  v_cvt_pk_bf16_f32 v39, v62, v63
  v_permlane16_swap_b32 v36, v38
  s_nop 0
  v_permlane16_swap_b32 v37, v39
  v_mfma_f32_16x16x32_bf16 v[92:95], a[12:15], v[136:139], 0
  buffer_store_dwordx4 v[36:39], v7, s[12:15], s65 offen offset:2048 sc1
  v_mfma_f32_16x16x32_bf16 v[92:95], a[124:127], v[140:143], v[92:95]
  s_waitcnt vmcnt(9)
  buffer_load_dwordx4 v[16:19], v2, s[12:15], s72 offen offset:0 sc1
  buffer_load_dwordx4 v[20:23], v2, s[12:15], s72 offen offset:1024 sc1
  buffer_load_dwordx4 v[180:183], v42, s[12:15], s70 offen offset:1024 sc1
  v_mfma_f32_16x16x32_bf16 v[96:99], a[0:3], v[144:147], 0
  s_waitcnt vmcnt(10)
  buffer_atomic_add v13, v33, s[12:15], s66 offen sc1
  v_mfma_f32_16x16x32_bf16 v[96:99], a[112:115], v[148:151], v[96:99]
  v_mfma_f32_16x16x32_bf16 v[100:103], a[4:7], v[144:147], 0
  v_mfma_f32_16x16x32_bf16 v[100:103], a[116:119], v[148:151], v[100:103]
  buffer_load_dwordx4 v[184:187], v43, s[12:15], s68 offen offset:1024 sc1
  v_mfma_f32_16x16x32_bf16 v[104:107], a[8:11], v[144:147], 0
  v_mfma_f32_16x16x32_bf16 v[104:107], a[120:123], v[148:151], v[104:107]
  v_mfma_f32_16x16x32_bf16 v[108:111], a[12:15], v[144:147], 0
  v_mfma_f32_16x16x32_bf16 v[108:111], a[124:127], v[148:151], v[108:111]
  s_waitcnt vmcnt(11)
  buffer_load_dwordx4 v[188:191], v43, s[12:15], s70 offen offset:1024 sc1
  v_mfma_f32_16x16x32_bf16 v[112:115], a[0:3], v[152:155], 0
  v_mfma_f32_16x16x32_bf16 v[112:115], a[112:115], v[156:159], v[112:115]
  v_mfma_f32_16x16x32_bf16 v[116:119], a[4:7], v[152:155], 0
  v_mfma_f32_16x16x32_bf16 v[116:119], a[116:119], v[156:159], v[116:119]
  buffer_load_dwordx4 v[192:195], v41, s[12:15], s68 offen offset:2048 sc1
  v_mfma_f32_16x16x32_bf16 v[120:123], a[8:11], v[152:155], 0
  v_mfma_f32_16x16x32_bf16 v[120:123], a[120:123], v[156:159], v[120:123]
  v_mfma_f32_16x16x32_bf16 v[124:127], a[12:15], v[152:155], 0
  v_mfma_f32_16x16x32_bf16 v[124:127], a[124:127], v[156:159], v[124:127]
  s_waitcnt vmcnt(11)
  buffer_load_dwordx4 v[196:199], v41, s[12:15], s70 offen offset:2048 sc1
  v_mfma_f32_16x16x32_bf16 v[64:67], a[16:19], v[160:163], v[64:67]
  v_mfma_f32_16x16x32_bf16 v[64:67], a[128:131], v[164:167], v[64:67]
  v_mfma_f32_16x16x32_bf16 v[68:71], a[20:23], v[160:163], v[68:71]
  v_mfma_f32_16x16x32_bf16 v[68:71], a[132:135], v[164:167], v[68:71]
  buffer_load_dwordx4 v[200:203], v42, s[12:15], s68 offen offset:2048 sc1
  v_mfma_f32_16x16x32_bf16 v[72:75], a[24:27], v[160:163], v[72:75]
  v_mfma_f32_16x16x32_bf16 v[72:75], a[136:139], v[164:167], v[72:75]
  v_mfma_f32_16x16x32_bf16 v[76:79], a[28:31], v[160:163], v[76:79]
  v_mfma_f32_16x16x32_bf16 v[76:79], a[140:143], v[164:167], v[76:79]
  s_waitcnt vmcnt(11)
  buffer_load_dwordx4 v[204:207], v42, s[12:15], s70 offen offset:2048 sc1
  v_mfma_f32_16x16x32_bf16 v[80:83], a[16:19], v[168:171], v[80:83]
  v_mov_b32 v9, 0
  buffer_atomic_add v9, v33, s[12:15], s67 offen sc0 sc1
  v_mfma_f32_16x16x32_bf16 v[80:83], a[128:131], v[172:175], v[80:83]
  v_mfma_f32_16x16x32_bf16 v[84:87], a[20:23], v[168:171], v[84:87]
  v_mfma_f32_16x16x32_bf16 v[84:87], a[132:135], v[172:175], v[84:87]
  buffer_load_dwordx4 v[208:211], v43, s[12:15], s68 offen offset:2048 sc1
  v_mfma_f32_16x16x32_bf16 v[88:91], a[24:27], v[168:171], v[88:91]
  v_mfma_f32_16x16x32_bf16 v[88:91], a[136:139], v[172:175], v[88:91]
  v_mfma_f32_16x16x32_bf16 v[92:95], a[28:31], v[168:171], v[92:95]
  v_mfma_f32_16x16x32_bf16 v[92:95], a[140:143], v[172:175], v[92:95]
  s_waitcnt vmcnt(9)
  buffer_load_dwordx4 v[212:215], v43, s[12:15], s70 offen offset:2048 sc1
  v_mfma_f32_16x16x32_bf16 v[96:99], a[16:19], v[176:179], v[96:99]
  v_mfma_f32_16x16x32_bf16 v[96:99], a[128:131], v[180:183], v[96:99]
  v_mfma_f32_16x16x32_bf16 v[100:103], a[20:23], v[176:179], v[100:103]
  v_mfma_f32_16x16x32_bf16 v[100:103], a[132:135], v[180:183], v[100:103]
  buffer_load_dwordx4 v[216:219], v41, s[12:15], s68 offen offset:3072 sc1
  v_mfma_f32_16x16x32_bf16 v[104:107], a[24:27], v[176:179], v[104:107]
  v_mfma_f32_16x16x32_bf16 v[104:107], a[136:139], v[180:183], v[104:107]
  v_mfma_f32_16x16x32_bf16 v[108:111], a[28:31], v[176:179], v[108:111]
  v_mfma_f32_16x16x32_bf16 v[108:111], a[140:143], v[180:183], v[108:111]
  s_waitcnt vmcnt(8)
  buffer_atomic_add v14, v33, s[12:15], s66 offen sc1
  buffer_load_dwordx4 v[220:223], v41, s[12:15], s70 offen offset:3072 sc1
  v_and_b32 v49, 0xffff0000, v16
  v_mfma_f32_16x16x32_bf16 v[112:115], a[16:19], v[184:187], v[112:115]
  v_lshlrev_b32 v48, 16, v16
  v_and_b32 v51, 0xffff0000, v17
  v_mfma_f32_16x16x32_bf16 v[112:115], a[128:131], v[188:191], v[112:115]
  v_lshlrev_b32 v50, 16, v17
  v_and_b32 v53, 0xffff0000, v18
  v_mfma_f32_16x16x32_bf16 v[116:119], a[20:23], v[184:187], v[116:119]
  v_lshlrev_b32 v52, 16, v18
  v_and_b32 v55, 0xffff0000, v19
  v_mfma_f32_16x16x32_bf16 v[116:119], a[132:135], v[188:191], v[116:119]
  buffer_load_dwordx4 v[224:227], v42, s[12:15], s68 offen offset:3072 sc1
  v_lshlrev_b32 v54, 16, v19
  v_mfma_f32_16x16x32_bf16 v[120:123], a[24:27], v[184:187], v[120:123]
  v_and_b32 v57, 0xffff0000, v20
  v_lshlrev_b32 v56, 16, v20
  v_mfma_f32_16x16x32_bf16 v[120:123], a[136:139], v[188:191], v[120:123]
  v_and_b32 v59, 0xffff0000, v21
  v_lshlrev_b32 v58, 16, v21
  v_mfma_f32_16x16x32_bf16 v[124:127], a[28:31], v[184:187], v[124:127]
  v_and_b32 v61, 0xffff0000, v22
  v_lshlrev_b32 v60, 16, v22
  v_mfma_f32_16x16x32_bf16 v[124:127], a[140:143], v[188:191], v[124:127]
  s_waitcnt vmcnt(9)
  buffer_load_dwordx4 v[228:231], v42, s[12:15], s70 offen offset:3072 sc1
  v_and_b32 v63, 0xffff0000, v23
  v_mfma_f32_16x16x32_bf16 v[80:83], a[32:35], v[192:195], v[80:83]
  v_lshlrev_b32 v62, 16, v23
  v_mfma_f32_16x16x32_bf16 v[80:83], a[144:147], v[196:199], v[80:83]
  v_mfma_f32_16x16x32_bf16 v[84:87], a[36:39], v[192:195], v[84:87]
  v_mfma_f32_16x16x32_bf16 v[84:87], a[148:151], v[196:199], v[84:87]
  buffer_load_dwordx4 v[232:235], v43, s[12:15], s68 offen offset:3072 sc1
  v_mfma_f32_16x16x32_bf16 v[88:91], a[40:43], v[192:195], v[88:91]
  v_mfma_f32_16x16x32_bf16 v[88:91], a[152:155], v[196:199], v[88:91]
  v_mfma_f32_16x16x32_bf16 v[92:95], a[44:47], v[192:195], v[92:95]
  v_mfma_f32_16x16x32_bf16 v[92:95], a[156:159], v[196:199], v[92:95]
  s_waitcnt vmcnt(9)
  buffer_load_dwordx4 v[236:239], v43, s[12:15], s70 offen offset:3072 sc1
  v_mfma_f32_16x16x32_bf16 v[96:99], a[32:35], v[200:203], v[96:99]
  v_mfma_f32_16x16x32_bf16 v[96:99], a[144:147], v[204:207], v[96:99]
  v_mfma_f32_16x16x32_bf16 v[100:103], a[36:39], v[200:203], v[100:103]
  s_waitcnt vmcnt(9)
  v_readfirstlane_b32 s99, v9
  s_nop 0
  s_bfe_u32 s99, s99, 0x80008
  s_cmp_lt_u32 s99, 8
  s_cbranch_scc1 L_spin9
L_back9:
  v_mfma_f32_16x16x32_bf16 v[100:103], a[148:151], v[204:207], v[100:103]
  buffer_load_dwordx4 v[240:243], v41, s[12:15], s69 offen offset:0 sc1
  v_mfma_f32_16x16x32_bf16 v[104:107], a[40:43], v[200:203], v[104:107]
  v_mfma_f32_16x16x32_bf16 v[104:107], a[152:155], v[204:207], v[104:107]
  v_mfma_f32_16x16x32_bf16 v[108:111], a[44:47], v[200:203], v[108:111]
  v_mfma_f32_16x16x32_bf16 v[108:111], a[156:159], v[204:207], v[108:111]
  s_waitcnt vmcnt(8)
  buffer_load_dwordx4 v[244:247], v41, s[12:15], s71 offen offset:0 sc1
  v_mfma_f32_16x16x32_bf16 v[112:115], a[32:35], v[208:211], v[112:115]
  v_mov_b32 v10, 0
  buffer_atomic_add v10, v33, s[12:15], s67 offen sc0 sc1
  v_mfma_f32_16x16x32_bf16 v[112:115], a[144:147], v[212:215], v[112:115]
  v_mfma_f32_16x16x32_bf16 v[116:119], a[36:39], v[208:211], v[116:119]
  v_mfma_f32_16x16x32_bf16 v[116:119], a[148:151], v[212:215], v[116:119]
  buffer_load_dwordx4 v[248:251], v42, s[12:15], s69 offen offset:0 sc1
  v_mfma_f32_16x16x32_bf16 v[120:123], a[40:43], v[208:211], v[120:123]
  v_mfma_f32_16x16x32_bf16 v[120:123], a[152:155], v[212:215], v[120:123]
  v_mfma_f32_16x16x32_bf16 v[124:127], a[44:47], v[208:211], v[124:127]
  v_mfma_f32_16x16x32_bf16 v[124:127], a[156:159], v[212:215], v[124:127]
  s_waitcnt vmcnt(8)
  buffer_load_dwordx4 v[252:255], v42, s[12:15], s71 offen offset:0 sc1
  v_mfma_f32_16x16x32_bf16 v[80:83], a[48:51], v[216:219], v[80:83]
  v_mfma_f32_16x16x32_bf16 v[80:83], a[160:163], v[220:223], v[80:83]
  v_mfma_f32_16x16x32_bf16 v[84:87], a[52:55], v[216:219], v[84:87]
  v_mfma_f32_16x16x32_bf16 v[84:87], a[164:167], v[220:223], v[84:87]
  buffer_load_dwordx4 v[128:131], v43, s[12:15], s69 offen offset:0 sc1
  v_mfma_f32_16x16x32_bf16 v[88:91], a[56:59], v[216:219], v[88:91]
  v_mfma_f32_16x16x32_bf16 v[88:91], a[168:171], v[220:223], v[88:91]
  v_mfma_f32_16x16x32_bf16 v[92:95], a[60:63], v[216:219], v[92:95]
  v_mfma_f32_16x16x32_bf16 v[92:95], a[172:175], v[220:223], v[92:95]
  s_waitcnt vmcnt(8)
  buffer_load_dwordx4 v[132:135], v43, s[12:15], s71 offen offset:0 sc1
  v_mfma_f32_16x16x32_bf16 v[96:99], a[48:51], v[224:227], v[96:99]
  v_mfma_f32_16x16x32_bf16 v[96:99], a[160:163], v[228:231], v[96:99]
  v_mfma_f32_16x16x32_bf16 v[100:103], a[52:55], v[224:227], v[100:103]
  v_mfma_f32_16x16x32_bf16 v[100:103], a[164:167], v[228:231], v[100:103]
  buffer_load_dwordx4 v[136:139], v41, s[12:15], s69 offen offset:1024 sc1
  v_mfma_f32_16x16x32_bf16 v[104:107], a[56:59], v[224:227], v[104:107]
  v_mfma_f32_16x16x32_bf16 v[104:107], a[168:171], v[228:231], v[104:107]
  v_mfma_f32_16x16x32_bf16 v[108:111], a[60:63], v[224:227], v[108:111]
  v_mfma_f32_16x16x32_bf16 v[108:111], a[172:175], v[228:231], v[108:111]
  s_waitcnt vmcnt(8)
  buffer_load_dwordx4 v[140:143], v41, s[12:15], s71 offen offset:1024 sc1
  v_mfma_f32_16x16x32_bf16 v[112:115], a[48:51], v[232:235], v[112:115]
  v_mfma_f32_16x16x32_bf16 v[112:115], a[160:163], v[236:239], v[112:115]
  v_mfma_f32_16x16x32_bf16 v[116:119], a[52:55], v[232:235], v[116:119]
  v_mfma_f32_16x16x32_bf16 v[116:119], a[164:167], v[236:239], v[116:119]
  v_mfma_f32_16x16x32_bf16 v[120:123], a[56:59], v[232:235], v[120:123]
  v_mfma_f32_16x16x32_bf16 v[120:123], a[168:171], v[236:239], v[120:123]
  v_mfma_f32_16x16x32_bf16 v[124:127], a[60:63], v[232:235], v[124:127]
  v_mfma_f32_16x16x32_bf16 v[124:127], a[172:175], v[236:239], v[124:127]
  s_waitcnt vmcnt(7)
  s_waitcnt vmcnt(6)
  v_readfirstlane_b32 s99, v10
  s_nop 0
  s_bfe_u32 s99, s99, 0x80010
  s_cmp_lt_u32 s99, 8
  s_cbranch_scc1 L_spin10
L_back10:
  v_mfma_f32_16x16x32_bf16 v[80:83], a[64:67], v[240:243], v[80:83]
  buffer_load_dwordx4 v[144:147], v41, s[12:15], s69 offen offset:2048 sc1
  buffer_load_dwordx4 v[148:151], v41, s[12:15], s71 offen offset:2048 sc1
  v_mfma_f32_16x16x32_bf16 v[80:83], a[176:179], v[244:247], v[80:83]
  v_mfma_f32_16x16x32_bf16 v[84:87], a[68:71], v[240:243], v[84:87]
  v_mfma_f32_16x16x32_bf16 v[84:87], a[180:183], v[244:247], v[84:87]
  v_mfma_f32_16x16x32_bf16 v[88:91], a[72:75], v[240:243], v[88:91]
  buffer_load_dwordx4 v[152:155], v42, s[12:15], s69 offen offset:1024 sc1
  v_mfma_f32_16x16x32_bf16 v[88:91], a[184:187], v[244:247], v[88:91]
  v_mfma_f32_16x16x32_bf16 v[92:95], a[76:79], v[240:243], v[92:95]
  v_mfma_f32_16x16x32_bf16 v[92:95], a[188:191], v[244:247], v[92:95]
  s_waitcnt vmcnt(7)
  v_mfma_f32_16x16x32_bf16 v[96:99], a[64:67], v[248:251], v[96:99]
  buffer_load_dwordx4 v[156:159], v42, s[12:15], s71 offen offset:1024 sc1
  v_mfma_f32_16x16x32_bf16 v[96:99], a[176:179], v[252:255], v[96:99]
  v_mfma_f32_16x16x32_bf16 v[100:103], a[68:71], v[248:251], v[100:103]
  v_mfma_f32_16x16x32_bf16 v[100:103], a[180:183], v[252:255], v[100:103]
  v_mfma_f32_16x16x32_bf16 v[104:107], a[72:75], v[248:251], v[104:107]
  buffer_load_dwordx4 v[160:163], v42, s[12:15], s69 offen offset:2048 sc1
  v_mfma_f32_16x16x32_bf16 v[104:107], a[184:187], v[252:255], v[104:107]
  v_mfma_f32_16x16x32_bf16 v[108:111], a[76:79], v[248:251], v[108:111]
  v_mfma_f32_16x16x32_bf16 v[108:111], a[188:191], v[252:255], v[108:111]
  s_waitcnt vmcnt(7)
  v_mfma_f32_16x16x32_bf16 v[112:115], a[64:67], v[128:131], v[112:115]
  buffer_load_dwordx4 v[164:167], v42, s[12:15], s71 offen offset:2048 sc1
  v_mfma_f32_16x16x32_bf16 v[112:115], a[176:179], v[132:135], v[112:115]
  v_mfma_f32_16x16x32_bf16 v[116:119], a[68:71], v[128:131], v[116:119]
  v_mfma_f32_16x16x32_bf16 v[116:119], a[180:183], v[132:135], v[116:119]
  v_mfma_f32_16x16x32_bf16 v[120:123], a[72:75], v[128:131], v[120:123]
  buffer_load_dwordx4 v[168:171], v43, s[12:15], s69 offen offset:1024 sc1
  v_mfma_f32_16x16x32_bf16 v[120:123], a[184:187], v[132:135], v[120:123]
  v_mfma_f32_16x16x32_bf16 v[124:127], a[76:79], v[128:131], v[124:127]
  v_mfma_f32_16x16x32_bf16 v[124:127], a[188:191], v[132:135], v[124:127]
  s_waitcnt vmcnt(7)
  v_mfma_f32_16x16x32_bf16 v[80:83], a[80:83], v[136:139], v[80:83]
  buffer_load_dwordx4 v[172:175], v43, s[12:15], s71 offen offset:1024 sc1
  v_mfma_f32_16x16x32_bf16 v[80:83], a[192:195], v[140:143], v[80:83]
  v_mfma_f32_16x16x32_bf16 v[84:87], a[84:87], v[136:139], v[84:87]
  v_mfma_f32_16x16x32_bf16 v[84:87], a[196:199], v[140:143], v[84:87]
  v_mfma_f32_16x16x32_bf16 v[88:91], a[88:91], v[136:139], v[88:91]
  buffer_load_dwordx4 v[176:179], v43, s[12:15], s69 offen offset:2048 sc1
  v_mfma_f32_16x16x32_bf16 v[88:91], a[200:203], v[140:143], v[88:91]
  v_mfma_f32_16x16x32_bf16 v[92:95], a[92:95], v[136:139], v[92:95]
  v_mfma_f32_16x16x32_bf16 v[92:95], a[204:207], v[140:143], v[92:95]
  s_waitcnt vmcnt(7)
  v_mfma_f32_16x16x32_bf16 v[80:83], a[96:99], v[144:147], v[80:83]
  buffer_load_dwordx4 v[180:183], v43, s[12:15], s71 offen offset:2048 sc1
  v_mfma_f32_16x16x32_bf16 v[80:83], a[208:211], v[148:151], v[80:83]
  v_mfma_f32_16x16x32_bf16 v[84:87], a[100:103], v[144:147], v[84:87]
  v_mfma_f32_16x16x32_bf16 v[84:87], a[212:215], v[148:151], v[84:87]
  v_mfma_f32_16x16x32_bf16 v[88:91], a[104:107], v[144:147], v[88:91]
  buffer_load_dwordx4 v[184:187], v40, s[12:15], s68 offen offset:2048 sc1
  v_mfma_f32_16x16x32_bf16 v[88:91], a[216:219], v[148:151], v[88:91]
  v_mfma_f32_16x16x32_bf16 v[92:95], a[108:111], v[144:147], v[92:95]
  v_mfma_f32_16x16x32_bf16 v[92:95], a[220:223], v[148:151], v[92:95]
  s_waitcnt vmcnt(7)
  v_mfma_f32_16x16x32_bf16 v[96:99], a[80:83], v[152:155], v[96:99]
  buffer_load_dwordx4 v[188:191], v40, s[12:15], s70 offen offset:2048 sc1
  v_mfma_f32_16x16x32_bf16 v[96:99], a[192:195], v[156:159], v[96:99]
  v_mfma_f32_16x16x32_bf16 v[100:103], a[84:87], v[152:155], v[100:103]
  v_mfma_f32_16x16x32_bf16 v[100:103], a[196:199], v[156:159], v[100:103]
  v_mfma_f32_16x16x32_bf16 v[104:107], a[88:91], v[152:155], v[104:107]
  buffer_load_dwordx4 v[192:195], v40, s[12:15], s68 offen offset:3072 sc1
  v_mfma_f32_16x16x32_bf16 v[104:107], a[200:203], v[156:159], v[104:107]
  v_mfma_f32_16x16x32_bf16 v[108:111], a[92:95], v[152:155], v[108:111]
  v_mfma_f32_16x16x32_bf16 v[108:111], a[204:207], v[156:159], v[108:111]
  s_waitcnt vmcnt(7)
  ds_write_b128 v44, v[80:83] offset:0
  v_mfma_f32_16x16x32_bf16 v[96:99], a[96:99], v[160:163], v[96:99]
  buffer_load_dwordx4 v[196:199], v40, s[12:15], s70 offen offset:3072 sc1
  v_mfma_f32_16x16x32_bf16 v[96:99], a[208:211], v[164:167], v[96:99]
  v_mfma_f32_16x16x32_bf16 v[100:103], a[100:103], v[160:163], v[100:103]
  ds_write_b128 v44, v[84:87] offset:1024
  v_mfma_f32_16x16x32_bf16 v[100:103], a[212:215], v[164:167], v[100:103]
  v_mfma_f32_16x16x32_bf16 v[104:107], a[104:107], v[160:163], v[104:107]
  buffer_load_dwordx4 v[200:203], v40, s[12:15], s69 offen offset:0 sc1
  v_mfma_f32_16x16x32_bf16 v[104:107], a[216:219], v[164:167], v[104:107]
  ds_write_b128 v44, v[88:91] offset:2048
  v_mfma_f32_16x16x32_bf16 v[108:111], a[108:111], v[160:163], v[108:111]
  v_mfma_f32_16x16x32_bf16 v[108:111], a[220:223], v[164:167], v[108:111]
  s_waitcnt vmcnt(7)
  v_mfma_f32_16x16x32_bf16 v[112:115], a[80:83], v[168:171], v[112:115]
  buffer_load_dwordx4 v[204:207], v40, s[12:15], s71 offen offset:0 sc1
  v_mfma_f32_16x16x32_bf16 v[112:115], a[192:195], v[172:175], v[112:115]
  v_mfma_f32_16x16x32_bf16 v[116:119], a[84:87], v[168:171], v[116:119]
  v_mfma_f32_16x16x32_bf16 v[116:119], a[196:199], v[172:175], v[116:119]
  ds_write_b128 v44, v[92:95] offset:3072
  v_mfma_f32_16x16x32_bf16 v[120:123], a[88:91], v[168:171], v[120:123]
  buffer_load_dwordx4 v[208:211], v40, s[12:15], s69 offen offset:1024 sc1
  v_mfma_f32_16x16x32_bf16 v[120:123], a[200:203], v[172:175], v[120:123]
  v_mfma_f32_16x16x32_bf16 v[124:127], a[92:95], v[168:171], v[124:127]
  ds_write_b128 v45, v[96:99] offset:4096
  v_mfma_f32_16x16x32_bf16 v[124:127], a[204:207], v[172:175], v[124:127]
  s_waitcnt vmcnt(7)
  v_mfma_f32_16x16x32_bf16 v[112:115], a[96:99], v[176:179], v[112:115]
  buffer_load_dwordx4 v[212:215], v40, s[12:15], s71 offen offset:1024 sc1
  v_mfma_f32_16x16x32_bf16 v[112:115], a[208:211], v[180:183], v[112:115]
  ds_write_b128 v45, v[100:103] offset:5120
  v_mfma_f32_16x16x32_bf16 v[116:119], a[100:103], v[176:179], v[116:119]
  v_mfma_f32_16x16x32_bf16 v[116:119], a[212:215], v[180:183], v[116:119]
  v_mfma_f32_16x16x32_bf16 v[120:123], a[104:107], v[176:179], v[120:123]
  buffer_load_dwordx4 v[216:219], v40, s[12:15], s69 offen offset:2048 sc1
  v_mfma_f32_16x16x32_bf16 v[120:123], a[216:219], v[180:183], v[120:123]
  v_mfma_f32_16x16x32_bf16 v[124:127], a[108:111], v[176:179], v[124:127]
  v_mfma_f32_16x16x32_bf16 v[124:127], a[220:223], v[180:183], v[124:127]
  s_waitcnt vmcnt(7)
  ds_write_b128 v45, v[104:107] offset:6144
  v_mfma_f32_16x16x32_bf16 v[64:67], a[32:35], v[184:187], v[64:67]
  buffer_load_dwordx4 v[220:223], v40, s[12:15], s71 offen offset:2048 sc1
  v_mfma_f32_16x16x32_bf16 v[64:67], a[144:147], v[188:191], v[64:67]
  v_mfma_f32_16x16x32_bf16 v[68:71], a[36:39], v[184:187], v[68:71]
  ds_write_b128 v45, v[108:111] offset:7168
  v_mfma_f32_16x16x32_bf16 v[68:71], a[148:151], v[188:191], v[68:71]
  v_mfma_f32_16x16x32_bf16 v[72:75], a[40:43], v[184:187], v[72:75]
  v_mfma_f32_16x16x32_bf16 v[72:75], a[152:155], v[188:191], v[72:75]
  ds_write_b128 v3, v[112:115] offset:8192
  v_mfma_f32_16x16x32_bf16 v[76:79], a[44:47], v[184:187], v[76:79]
  v_mfma_f32_16x16x32_bf16 v[76:79], a[156:159], v[188:191], v[76:79]
  s_waitcnt vmcnt(6)
  v_mfma_f32_16x16x32_bf16 v[64:67], a[48:51], v[192:195], v[64:67]
  ds_write_b128 v3, v[116:119] offset:9216
  v_mfma_f32_16x16x32_bf16 v[64:67], a[160:163], v[196:199], v[64:67]
  v_mfma_f32_16x16x32_bf16 v[68:71], a[52:55], v[192:195], v[68:71]
  v_mfma_f32_16x16x32_bf16 v[68:71], a[164:167], v[196:199], v[68:71]
  ds_write_b128 v3, v[120:123] offset:10240
  v_mfma_f32_16x16x32_bf16 v[72:75], a[56:59], v[192:195], v[72:75]
  v_mfma_f32_16x16x32_bf16 v[72:75], a[168:171], v[196:199], v[72:75]
  v_mfma_f32_16x16x32_bf16 v[76:79], a[60:63], v[192:195], v[76:79]
  ds_write_b128 v3, v[124:127] offset:11264
  v_mfma_f32_16x16x32_bf16 v[76:79], a[172:175], v[196:199], v[76:79]
  s_waitcnt vmcnt(4)
  v_mfma_f32_16x16x32_bf16 v[64:67], a[64:67], v[200:203], v[64:67]
  s_waitcnt lgkmcnt(0)
  s_barrier
  ds_read_b128 v[80:83], v15 offset:0
  ds_read_b128 v[84:87], v15 offset:1024
  v_mfma_f32_16x16x32_bf16 v[64:67], a[176:179], v[204:207], v[64:67]
  ds_read_b128 v[88:91], v15 offset:2048
  ds_read_b128 v[92:95], v15 offset:3072
  v_mfma_f32_16x16x32_bf16 v[68:71], a[68:71], v[200:203], v[68:71]
  ds_read_b128 v[96:99], v15 offset:4096
  ds_read_b128 v[100:103], v15 offset:5120
  v_mfma_f32_16x16x32_bf16 v[68:71], a[180:183], v[204:207], v[68:71]
  ds_read_b128 v[104:107], v15 offset:6144
  ds_read_b128 v[108:111], v15 offset:7168
  v_mfma_f32_16x16x32_bf16 v[72:75], a[72:75], v[200:203], v[72:75]
  ds_read_b128 v[112:115], v15 offset:8192
  ds_read_b128 v[116:119], v15 offset:9216
  v_mfma_f32_16x16x32_bf16 v[72:75], a[184:187], v[204:207], v[72:75]
  ds_read_b128 v[120:123], v15 offset:10240
  ds_read_b128 v[124:127], v15 offset:11264
  v_mfma_f32_16x16x32_bf16 v[76:79], a[76:79], v[200:203], v[76:79]
  v_mfma_f32_16x16x32_bf16 v[76:79], a[188:191], v[204:207], v[76:79]
  s_waitcnt vmcnt(2)
  s_waitcnt lgkmcnt(8)
  v_add_f32 v63, v63, v95
  v_add_f32 v62, v62, v94
  v_mfma_f32_16x16x32_bf16 v[64:67], a[80:83], v[208:211], v[64:67]
  v_add_f32 v61, v61, v93
  v_add_f32 v60, v60, v92
  v_mfma_f32_16x16x32_bf16 v[64:67], a[192:195], v[212:215], v[64:67]
  v_add_f32 v59, v59, v91
  v_add_f32 v58, v58, v90
  v_mfma_f32_16x16x32_bf16 v[68:71], a[84:87], v[208:211], v[68:71]
  v_add_f32 v57, v57, v89
  v_add_f32 v56, v56, v88
  v_mfma_f32_16x16x32_bf16 v[68:71], a[196:199], v[212:215], v[68:71]
  v_add_f32 v55, v55, v87
  v_add_f32 v54, v54, v86
  v_mfma_f32_16x16x32_bf16 v[72:75], a[88:91], v[208:211], v[72:75]
  v_add_f32 v53, v53, v85
  v_add_f32 v52, v52, v84
  v_mfma_f32_16x16x32_bf16 v[72:75], a[200:203], v[212:215], v[72:75]
  v_add_f32 v51, v51, v83
  v_add_f32 v50, v50, v82
  v_mfma_f32_16x16x32_bf16 v[76:79], a[92:95], v[208:211], v[76:79]
  v_add_f32 v49, v49, v81
  v_add_f32 v48, v48, v80
  v_mfma_f32_16x16x32_bf16 v[76:79], a[204:207], v[212:215], v[76:79]
  s_waitcnt vmcnt(0)
  s_waitcnt lgkmcnt(4)
  v_add_f32 v63, v63, v111
  v_add_f32 v62, v62, v110
  v_mfma_f32_16x16x32_bf16 v[64:67], a[96:99], v[216:219], v[64:67]
  v_add_f32 v61, v61, v109
  v_add_f32 v60, v60, v108
  v_mfma_f32_16x16x32_bf16 v[64:67], a[208:211], v[220:223], v[64:67]
  v_add_f32 v59, v59, v107
  v_add_f32 v58, v58, v106
  v_mfma_f32_16x16x32_bf16 v[68:71], a[100:103], v[216:219], v[68:71]
  v_add_f32 v57, v57, v105
  v_add_f32 v56, v56, v104
  v_mfma_f32_16x16x32_bf16 v[68:71], a[212:215], v[220:223], v[68:71]
  v_add_f32 v55, v55, v103
  v_add_f32 v54, v54, v102
  v_mfma_f32_16x16x32_bf16 v[72:75], a[104:107], v[216:219], v[72:75]
  v_add_f32 v53, v53, v101
  v_add_f32 v52, v52, v100
  v_mfma_f32_16x16x32_bf16 v[72:75], a[216:219], v[220:223], v[72:75]
  v_add_f32 v51, v51, v99
  v_add_f32 v50, v50, v98
  v_mfma_f32_16x16x32_bf16 v[76:79], a[108:111], v[216:219], v[76:79]
  v_add_f32 v49, v49, v97
  v_add_f32 v48, v48, v96
  v_mfma_f32_16x16x32_bf16 v[76:79], a[220:223], v[220:223], v[76:79]
  s_waitcnt lgkmcnt(0)
  v_add_f32 v63, v63, v127
  v_add_f32 v62, v62, v126
  v_add_f32 v61, v61, v125
  v_add_f32 v60, v60, v124
  v_add_f32 v59, v59, v123
  v_add_f32 v58, v58, v122
  v_add_f32 v57, v57, v121
  v_add_f32 v56, v56, v120
  v_add_f32 v55, v55, v119
  v_add_f32 v54, v54, v118
  v_add_f32 v53, v53, v117
  v_add_f32 v52, v52, v116
  v_add_f32 v51, v51, v115
  v_add_f32 v50, v50, v114
  v_add_f32 v49, v49, v113
  v_add_f32 v48, v48, v112
  v_pk_add_f32 v[64:65], v[64:65], v[48:49]
  v_pk_add_f32 v[66:67], v[66:67], v[50:51]
  v_pk_add_f32 v[68:69], v[68:69], v[52:53]
  v_pk_add_f32 v[70:71], v[70:71], v[54:55]
  v_cvt_pk_bf16_f32 v24, v64, v65
  v_cvt_pk_bf16_f32 v25, v66, v67
  v_cvt_pk_bf16_f32 v26, v68, v69
  v_cvt_pk_bf16_f32 v27, v70, v71
  buffer_store_dwordx4 v[24:27], v46, s[28:31], s73 offen offset:0 nt
  v_pk_add_f32 v[72:73], v[72:73], v[56:57]
  v_pk_add_f32 v[74:75], v[74:75], v[58:59]
  v_pk_add_f32 v[76:77], v[76:77], v[60:61]
  v_pk_add_f32 v[78:79], v[78:79], v[62:63]
  v_cvt_pk_bf16_f32 v28, v72, v73
  v_cvt_pk_bf16_f32 v29, v74, v75
  v_cvt_pk_bf16_f32 v30, v76, v77
  v_cvt_pk_bf16_f32 v31, v78, v79
  buffer_store_dwordx4 v[28:31], v46, s[28:31], s73 offen offset:64 nt
  s_endpgm
L_spin1:
  s_mov_b32 s98, 0
L_poll11:
  buffer_load_dword v254, v33, s[32:35], 0 offen sc1
  s_add_u32 s98, s98, 1
  s_waitcnt vmcnt(0)
  v_readfirstlane_b32 s99, v254
  s_nop 0
  s_cmp_lt_u32 s99, 33
  s_cbranch_scc0 L_pdone11
  s_sleep 2
  s_cmp_lt_u32 s98, 262144
  s_cbranch_scc1 L_poll11
L_pdone11:
  s_branch L_back1
L_spin2:
  s_mov_b32 s98, 0
L_poll12:
  v_mov_b32 v27, 0
  buffer_atomic_add v27, v33, s[12:15], s47 offen sc0 sc1
  s_add_u32 s98, s98, 1
  s_waitcnt vmcnt(0)
  v_readfirstlane_b32 s99, v27
  s_nop 0
  s_cmp_lt_u32 s99, s3
  s_cbranch_scc0 L_pdone12
  s_cmp_lt_u32 s98, 262144
  s_cbranch_scc1 L_poll12
L_pdone12:
  s_branch L_back2
L_spin3:
  s_mov_b32 s98, 0
L_poll13:
  v_mov_b32 v28, 0
  buffer_atomic_add v28, v8, s[12:15], 0 offen sc0 sc1
  s_add_u32 s98, s98, 1
  s_waitcnt vmcnt(0)
  v_cmp_gt_u32 vcc, v41, v28
  s_nop 0
  s_cmp_lg_u32 vcc_lo, 0
  s_cbranch_scc0 L_pdone13
  s_sleep 6
  s_cmp_lt_u32 s98, 262144
  s_cbranch_scc1 L_poll13
L_pdone13:
  s_branch L_back3
L_spin4:
  s_mov_b32 s98, 0
L_poll14:
  v_mov_b32 v26, 0
  buffer_atomic_add v26, v33, s[12:15], s87 offen sc0 sc1
  s_add_u32 s98, s98, 1
  s_waitcnt vmcnt(0)
  v_readfirstlane_b32 s99, v26
  s_nop 0
  s_cmp_lt_u32 s99, 8
  s_cbranch_scc0 L_pdone14
  s_cmp_lt_u32 s98, 262144
  s_cbranch_scc1 L_poll14
L_pdone14:
  s_branch L_back4
L_spin5:
  s_mov_b32 s98, 0
L_poll15:
  v_mov_b32 v60, 0
  buffer_atomic_add v60, v33, s[12:15], s54 offen sc0 sc1
  s_add_u32 s98, s98, 1
  s_waitcnt vmcnt(0)
  v_readfirstlane_b32 s99, v60
  s_nop 0
  s_cmp_lt_u32 s99, 8
  s_cbranch_scc0 L_pdone15
  s_cmp_lt_u32 s98, 262144
  s_cbranch_scc1 L_poll15
L_pdone15:
  s_branch L_back5
L_spin6:
  s_mov_b32 s98, 0
L_poll16:
  v_mov_b32 v9, 0
  buffer_atomic_add v9, v29, s[12:15], s89 offen sc0 sc1
  s_add_u32 s98, s98, 1
  s_waitcnt vmcnt(0)
  v_cmp_gt_u32 vcc, v30, v9
  s_nop 0
  s_cmp_lg_u32 vcc_lo, 0
  s_cbranch_scc0 L_pdone16
  s_cmp_lt_u32 s98, 262144
  s_cbranch_scc1 L_poll16
L_pdone16:
  s_branch L_back6
L_spin7:
  s_mov_b32 s98, 0
  v_mov_b32 v10, 0
  buffer_atomic_add v10, v29, s[12:15], s76 offen sc0 sc1
  s_sleep 4
L_pp17:
  v_mov_b32 v28, 0
  buffer_atomic_add v28, v29, s[12:15], s76 offen sc0 sc1
  s_waitcnt vmcnt(1)
  v_cmp_gt_u32 vcc, v30, v10
  s_nop 0
  s_cmp_lg_u32 vcc_lo, 0
  s_cbranch_scc0 L_ppd17
  v_mov_b32 v10, 0
  buffer_atomic_add v10, v29, s[12:15], s76 offen sc0 sc1
  s_waitcnt vmcnt(1)
  v_cmp_gt_u32 vcc, v30, v28
  s_nop 0
  s_cmp_lg_u32 vcc_lo, 0
  s_cbranch_scc0 L_ppd17
  s_add_u32 s98, s98, 1
  s_cmp_lt_u32 s98, 262144
  s_cbranch_scc1 L_pp17
L_ppd17:
  s_branch L_back7
L_spin8:
  s_mov_b32 s98, 0
L_poll18:
  v_mov_b32 v9, 0
  buffer_atomic_add v9, v33, s[12:15], s67 offen sc0 sc1
  s_add_u32 s98, s98, 1
  s_waitcnt vmcnt(0)
  v_readfirstlane_b32 s99, v9
  s_nop 0
  s_bfe_u32 s99, s99, 0x80000
  s_cmp_lt_u32 s99, 8
  s_cbranch_scc0 L_pdone18
  s_sleep 2
  s_cmp_lt_u32 s98, 262144
  s_cbranch_scc1 L_poll18
L_pdone18:
  s_branch L_back8
L_spin9:
  s_mov_b32 s98, 0
L_poll19:
  v_mov_b32 v9, 0
  buffer_atomic_add v9, v33, s[12:15], s67 offen sc0 sc1
  s_add_u32 s98, s98, 1
  s_waitcnt vmcnt(0)
  v_readfirstlane_b32 s99, v9
  s_nop 0
  s_bfe_u32 s99, s99, 0x80008
  s_cmp_lt_u32 s99, 8
  s_cbranch_scc0 L_pdone19
  s_sleep 2
  s_cmp_lt_u32 s98, 262144
  s_cbranch_scc1 L_poll19
L_pdone19:
  s_branch L_back9
L_spin10:
  s_mov_b32 s98, 0
L_poll20:
  v_mov_b32 v10, 0
  buffer_atomic_add v10, v33, s[12:15], s67 offen sc0 sc1
  s_add_u32 s98, s98, 1
  s_waitcnt vmcnt(0)
  v_readfirstlane_b32 s99, v10
  s_nop 0
  s_bfe_u32 s99, s99, 0x80010
  s_cmp_lt_u32 s99, 8
  s_cbranch_scc0 L_pdone20
  s_sleep 2
  s_cmp_lt_u32 s98, 262144
  s_cbranch_scc1 L_poll20
L_pdone20:
  s_branch L_back10
L_safe:
  s_waitcnt vmcnt(0)
  s_nop 15
  v_cmp_le_i32 s[64:65], 0, v252
  v_cmp_le_i32 s[66:67], 1, v252
  v_cmp_le_i32 s[68:69], 2, v252
  v_cmp_le_i32 s[70:71], 3, v252
  v_cmp_le_i32 s[72:73], 4, v252
  v_cmp_le_i32 s[74:75], 5, v252
  v_cmp_le_i32 s[76:77], 6, v252
  v_cmp_le_i32 s[78:79], 7, v252
  v_cmp_le_i32 s[80:81], 16, v252
  v_cmp_le_i32 s[82:83], 17, v252
  v_cmp_le_i32 s[84:85], 18, v252
  v_cmp_le_i32 s[86:87], 19, v252
  v_cmp_le_i32 s[88:89], 20, v252
  v_cmp_le_i32 s[90:91], 21, v252
  v_cmp_le_i32 s[92:93], 22, v252
  v_cmp_le_i32 s[94:95], 23, v252
  v_mov_b32 v24, 0xff800000
  s_lshl_b32 s62, s37, 1
  s_add_u32 s62, s62, 1
  s_min_u32 s62, s62, 8
  v_mov_b32 v25, v24
  s_mov_b32 s63, 0
  v_add_u32 v26, 37008, v6
L_s1_0:
  ds_read_b128 v[144:147], v26
  s_waitcnt lgkmcnt(0)
  v_mfma_f32_32x32x16_bf16 v[64:79], v[144:147], v[48:51], 0
  s_nop 11
  s_cmp_lg_u32 s63, 0
  s_cbranch_scc1 L_m1_0_a
  v_cndmask_b32 v64, v24, v64, s[64:65]
  v_cndmask_b32 v65, v24, v65, s[66:67]
  v_cndmask_b32 v66, v24, v66, s[68:69]
  v_cndmask_b32 v67, v24, v67, s[70:71]
  v_cndmask_b32 v68, v24, v68, s[72:73]
  v_cndmask_b32 v69, v24, v69, s[74:75]
  v_cndmask_b32 v70, v24, v70, s[76:77]
  v_cndmask_b32 v71, v24, v71, s[78:79]
  v_cndmask_b32 v72, v24, v72, s[80:81]
  v_cndmask_b32 v73, v24, v73, s[82:83]
  v_cndmask_b32 v74, v24, v74, s[84:85]
  v_cndmask_b32 v75, v24, v75, s[86:87]
  v_cndmask_b32 v76, v24, v76, s[88:89]
  v_cndmask_b32 v77, v24, v77, s[90:91]
  v_cndmask_b32 v78, v24, v78, s[92:93]
  v_cndmask_b32 v79, v24, v79, s[94:95]
L_m1_0_a:
  s_cmp_lg_u32 s63, 8
  s_cbranch_scc1 L_m1_0_b
  v_cndmask_b32 v64, v64, v24, s[64:65]
  v_cndmask_b32 v65, v65, v24, s[66:67]
  v_cndmask_b32 v66, v66, v24, s[68:69]
  v_cndmask_b32 v67, v67, v24, s[70:71]
  v_cndmask_b32 v68, v68, v24, s[72:73]
  v_cndmask_b32 v69, v69, v24, s[74:75]
  v_cndmask_b32 v70, v70, v24, s[76:77]
  v_cndmask_b32 v71, v71, v24, s[78:79]
  v_cndmask_b32 v72, v72, v24, s[80:81]
  v_cndmask_b32 v73, v73, v24, s[82:83]
  v_cndmask_b32 v74, v74, v24, s[84:85]
  v_cndmask_b32 v75, v75, v24, s[86:87]
  v_cndmask_b32 v76, v76, v24, s[88:89]
  v_cndmask_b32 v77, v77, v24, s[90:91]
  v_cndmask_b32 v78, v78, v24, s[92:93]
  v_cndmask_b32 v79, v79, v24, s[94:95]
L_m1_0_b:
  v_max3_f32 v25, v25, v64, v65
  v_max3_f32 v25, v25, v66, v67
  v_max3_f32 v25, v25, v68, v69
  v_max3_f32 v25, v25, v70, v71
  v_max3_f32 v25, v25, v72, v73
  v_max3_f32 v25, v25, v74, v75
  v_max3_f32 v25, v25, v76, v77
  v_max3_f32 v25, v25, v78, v79
  v_subrev_u32 v26, 4112, v26
  s_add_u32 s63, s63, 1
  s_cmp_le_u32 s63, s62
  s_cbranch_scc1 L_s1_0
  v_mov_b32 v27, v25
  s_nop 1
  v_permlane32_swap_b32 v25, v27
  v_max_f32 v25, v25, v27
  v_sub_f32 v80, 0, v25
  v_mov_b32 v192, 0
  v_sub_f32 v81, 0, v25
  v_mov_b32 v193, 0
  v_sub_f32 v82, 0, v25
  v_mov_b32 v194, 0
  v_sub_f32 v83, 0, v25
  v_mov_b32 v195, 0
  v_sub_f32 v84, 0, v25
  v_mov_b32 v196, 0
  v_sub_f32 v85, 0, v25
  v_mov_b32 v197, 0
  v_sub_f32 v86, 0, v25
  v_mov_b32 v198, 0
  v_sub_f32 v87, 0, v25
  v_mov_b32 v199, 0
  v_sub_f32 v88, 0, v25
  v_mov_b32 v200, 0
  v_sub_f32 v89, 0, v25
  v_mov_b32 v201, 0
  v_sub_f32 v90, 0, v25
  v_mov_b32 v202, 0
  v_sub_f32 v91, 0, v25
  v_mov_b32 v203, 0
  v_sub_f32 v92, 0, v25
  v_mov_b32 v204, 0
  v_sub_f32 v93, 0, v25
  v_mov_b32 v205, 0
  v_sub_f32 v94, 0, v25
  v_mov_b32 v206, 0
  v_sub_f32 v95, 0, v25
  v_mov_b32 v207, 0
  s_mov_b32 s63, 0
  v_add_u32 v26, 37008, v6
  v_add_u32 v25, 37008, v4
  v_add_u32 v27, 37008, v5
L_s2_0:
  ds_read_b128 v[144:147], v26
  ds_read_b128 v[160:163], v25
  ds_read_b128 v[164:167], v27
  s_waitcnt lgkmcnt(2)
  v_mfma_f32_32x32x16_bf16 v[64:79], v[144:147], v[48:51], v[80:95]
  s_nop 11
  s_cmp_lg_u32 s63, 0
  s_cbranch_scc1 L_m2_0_a
  v_cndmask_b32 v64, v24, v64, s[64:65]
  v_cndmask_b32 v65, v24, v65, s[66:67]
  v_cndmask_b32 v66, v24, v66, s[68:69]
  v_cndmask_b32 v67, v24, v67, s[70:71]
  v_cndmask_b32 v68, v24, v68, s[72:73]
  v_cndmask_b32 v69, v24, v69, s[74:75]
  v_cndmask_b32 v70, v24, v70, s[76:77]
  v_cndmask_b32 v71, v24, v71, s[78:79]
  v_cndmask_b32 v72, v24, v72, s[80:81]
  v_cndmask_b32 v73, v24, v73, s[82:83]
  v_cndmask_b32 v74, v24, v74, s[84:85]
  v_cndmask_b32 v75, v24, v75, s[86:87]
  v_cndmask_b32 v76, v24, v76, s[88:89]
  v_cndmask_b32 v77, v24, v77, s[90:91]
  v_cndmask_b32 v78, v24, v78, s[92:93]
  v_cndmask_b32 v79, v24, v79, s[94:95]
L_m2_0_a:
  s_cmp_lg_u32 s63, 8
  s_cbranch_scc1 L_m2_0_b
  v_cndmask_b32 v64, v64, v24, s[64:65]
  v_cndmask_b32 v65, v65, v24, s[66:67]
  v_cndmask_b32 v66, v66, v24, s[68:69]
  v_cndmask_b32 v67, v67, v24, s[70:71]
  v_cndmask_b32 v68, v68, v24, s[72:73]
  v_cndmask_b32 v69, v69, v24, s[74:75]
  v_cndmask_b32 v70, v70, v24, s[76:77]
  v_cndmask_b32 v71, v71, v24, s[78:79]
  v_cndmask_b32 v72, v72, v24, s[80:81]
  v_cndmask_b32 v73, v73, v24, s[82:83]
  v_cndmask_b32 v74, v74, v24, s[84:85]
  v_cndmask_b32 v75, v75, v24, s[86:87]
  v_cndmask_b32 v76, v76, v24, s[88:89]
  v_cndmask_b32 v77, v77, v24, s[90:91]
  v_cndmask_b32 v78, v78, v24, s[92:93]
  v_cndmask_b32 v79, v79, v24, s[94:95]
L_m2_0_b:
  v_exp_f32 v64, v64
  v_exp_f32 v65, v65
  v_exp_f32 v66, v66
  v_exp_f32 v67, v67
  v_exp_f32 v68, v68
  v_exp_f32 v69, v69
  v_exp_f32 v70, v70
  v_exp_f32 v71, v71
  v_exp_f32 v72, v72
  v_exp_f32 v73, v73
  v_exp_f32 v74, v74
  v_exp_f32 v75, v75
  v_exp_f32 v76, v76
  v_exp_f32 v77, v77
  v_exp_f32 v78, v78
  v_exp_f32 v79, v79
  v_cvt_pk_bf16_f32 v112, v64, v65
  v_cvt_pk_bf16_f32 v113, v66, v67
  v_cvt_pk_bf16_f32 v114, v68, v69
  v_cvt_pk_bf16_f32 v115, v70, v71
  v_cvt_pk_bf16_f32 v116, v72, v73
  v_cvt_pk_bf16_f32 v117, v74, v75
  v_cvt_pk_bf16_f32 v118, v76, v77
  v_cvt_pk_bf16_f32 v119, v78, v79
  s_waitcnt lgkmcnt(1)
  v_mfma_f32_32x32x16_bf16 v[192:207], v[160:163], v[112:115], v[192:207]
  s_waitcnt lgkmcnt(0)
  v_mfma_f32_32x32x16_bf16 v[192:207], v[164:167], v[116:119], v[192:207]
  s_nop 3
  v_subrev_u32 v26, 4112, v26
  v_subrev_u32 v25, 4112, v25
  v_subrev_u32 v27, 4112, v27
  s_add_u32 s63, s63, 1
  s_cmp_le_u32 s63, s62
  s_cbranch_scc1 L_s2_0
  s_nop 11
  s_lshl_b32 s62, s37, 1
  s_add_u32 s62, s62, 0
  s_min_u32 s62, s62, 8
  v_mov_b32 v25, v24
  s_mov_b32 s63, 0
  v_add_u32 v26, 32896, v6
L_s1_1:
  ds_read_b128 v[144:147], v26
  s_waitcnt lgkmcnt(0)
  v_mfma_f32_32x32x16_bf16 v[64:79], v[144:147], v[52:55], 0
  s_nop 11
  s_cmp_lg_u32 s63, 0
  s_cbranch_scc1 L_m1_1_a
  v_cndmask_b32 v64, v24, v64, s[64:65]
  v_cndmask_b32 v65, v24, v65, s[66:67]
  v_cndmask_b32 v66, v24, v66, s[68:69]
  v_cndmask_b32 v67, v24, v67, s[70:71]
  v_cndmask_b32 v68, v24, v68, s[72:73]
  v_cndmask_b32 v69, v24, v69, s[74:75]
  v_cndmask_b32 v70, v24, v70, s[76:77]
  v_cndmask_b32 v71, v24, v71, s[78:79]
  v_cndmask_b32 v72, v24, v72, s[80:81]
  v_cndmask_b32 v73, v24, v73, s[82:83]
  v_cndmask_b32 v74, v24, v74, s[84:85]
  v_cndmask_b32 v75, v24, v75, s[86:87]
  v_cndmask_b32 v76, v24, v76, s[88:89]
  v_cndmask_b32 v77, v24, v77, s[90:91]
  v_cndmask_b32 v78, v24, v78, s[92:93]
  v_cndmask_b32 v79, v24, v79, s[94:95]
L_m1_1_a:
  s_cmp_lg_u32 s63, 8
  s_cbranch_scc1 L_m1_1_b
  v_cndmask_b32 v64, v64, v24, s[64:65]
  v_cndmask_b32 v65, v65, v24, s[66:67]
  v_cndmask_b32 v66, v66, v24, s[68:69]
  v_cndmask_b32 v67, v67, v24, s[70:71]
  v_cndmask_b32 v68, v68, v24, s[72:73]
  v_cndmask_b32 v69, v69, v24, s[74:75]
  v_cndmask_b32 v70, v70, v24, s[76:77]
  v_cndmask_b32 v71, v71, v24, s[78:79]
  v_cndmask_b32 v72, v72, v24, s[80:81]
  v_cndmask_b32 v73, v73, v24, s[82:83]
  v_cndmask_b32 v74, v74, v24, s[84:85]
  v_cndmask_b32 v75, v75, v24, s[86:87]
  v_cndmask_b32 v76, v76, v24, s[88:89]
  v_cndmask_b32 v77, v77, v24, s[90:91]
  v_cndmask_b32 v78, v78, v24, s[92:93]
  v_cndmask_b32 v79, v79, v24, s[94:95]
L_m1_1_b:
  v_max3_f32 v25, v25, v64, v65
  v_max3_f32 v25, v25, v66, v67
  v_max3_f32 v25, v25, v68, v69
  v_max3_f32 v25, v25, v70, v71
  v_max3_f32 v25, v25, v72, v73
  v_max3_f32 v25, v25, v74, v75
  v_max3_f32 v25, v25, v76, v77
  v_max3_f32 v25, v25, v78, v79
  v_subrev_u32 v26, 4112, v26
  s_add_u32 s63, s63, 1
  s_cmp_le_u32 s63, s62
  s_cbranch_scc1 L_s1_1
  v_mov_b32 v27, v25
  s_nop 1
  v_permlane32_swap_b32 v25, v27
  v_max_f32 v25, v25, v27
  v_sub_f32 v80, 0, v25
  v_mov_b32 v208, 0
  v_sub_f32 v81, 0, v25
  v_mov_b32 v209, 0
  v_sub_f32 v82, 0, v25
  v_mov_b32 v210, 0
  v_sub_f32 v83, 0, v25
  v_mov_b32 v211, 0
  v_sub_f32 v84, 0, v25
  v_mov_b32 v212, 0
  v_sub_f32 v85, 0, v25
  v_mov_b32 v213, 0
  v_sub_f32 v86, 0, v25
  v_mov_b32 v214, 0
  v_sub_f32 v87, 0, v25
  v_mov_b32 v215, 0
  v_sub_f32 v88, 0, v25
  v_mov_b32 v216, 0
  v_sub_f32 v89, 0, v25
  v_mov_b32 v217, 0
  v_sub_f32 v90, 0, v25
  v_mov_b32 v218, 0
  v_sub_f32 v91, 0, v25
  v_mov_b32 v219, 0
  v_sub_f32 v92, 0, v25
  v_mov_b32 v220, 0
  v_sub_f32 v93, 0, v25
  v_mov_b32 v221, 0
  v_sub_f32 v94, 0, v25
  v_mov_b32 v222, 0
  v_sub_f32 v95, 0, v25
  v_mov_b32 v223, 0
  s_mov_b32 s63, 0
  v_add_u32 v26, 32896, v6
  v_add_u32 v25, 32896, v4
  v_add_u32 v27, 32896, v5
L_s2_1:
  ds_read_b128 v[144:147], v26
  ds_read_b128 v[160:163], v25
  ds_read_b128 v[164:167], v27
  s_waitcnt lgkmcnt(2)
  v_mfma_f32_32x32x16_bf16 v[64:79], v[144:147], v[52:55], v[80:95]
  s_nop 11
  s_cmp_lg_u32 s63, 0
  s_cbranch_scc1 L_m2_1_a
  v_cndmask_b32 v64, v24, v64, s[64:65]
  v_cndmask_b32 v65, v24, v65, s[66:67]
  v_cndmask_b32 v66, v24, v66, s[68:69]
  v_cndmask_b32 v67, v24, v67, s[70:71]
  v_cndmask_b32 v68, v24, v68, s[72:73]
  v_cndmask_b32 v69, v24, v69, s[74:75]
  v_cndmask_b32 v70, v24, v70, s[76:77]
  v_cndmask_b32 v71, v24, v71, s[78:79]
  v_cndmask_b32 v72, v24, v72, s[80:81]
  v_cndmask_b32 v73, v24, v73, s[82:83]
  v_cndmask_b32 v74, v24, v74, s[84:85]
  v_cndmask_b32 v75, v24, v75, s[86:87]
  v_cndmask_b32 v76, v24, v76, s[88:89]
  v_cndmask_b32 v77, v24, v77, s[90:91]
  v_cndmask_b32 v78, v24, v78, s[92:93]
  v_cndmask_b32 v79, v24, v79, s[94:95]
L_m2_1_a:
  s_cmp_lg_u32 s63, 8
  s_cbranch_scc1 L_m2_1_b
  v_cndmask_b32 v64, v64, v24, s[64:65]
  v_cndmask_b32 v65, v65, v24, s[66:67]
  v_cndmask_b32 v66, v66, v24, s[68:69]
  v_cndmask_b32 v67, v67, v24, s[70:71]
  v_cndmask_b32 v68, v68, v24, s[72:73]
  v_cndmask_b32 v69, v69, v24, s[74:75]
  v_cndmask_b32 v70, v70, v24, s[76:77]
  v_cndmask_b32 v71, v71, v24, s[78:79]
  v_cndmask_b32 v72, v72, v24, s[80:81]
  v_cndmask_b32 v73, v73, v24, s[82:83]
  v_cndmask_b32 v74, v74, v24, s[84:85]
  v_cndmask_b32 v75, v75, v24, s[86:87]
  v_cndmask_b32 v76, v76, v24, s[88:89]
  v_cndmask_b32 v77, v77, v24, s[90:91]
  v_cndmask_b32 v78, v78, v24, s[92:93]
  v_cndmask_b32 v79, v79, v24, s[94:95]
L_m2_1_b:
  v_exp_f32 v64, v64
  v_exp_f32 v65, v65
  v_exp_f32 v66, v66
  v_exp_f32 v67, v67
  v_exp_f32 v68, v68
  v_exp_f32 v69, v69
  v_exp_f32 v70, v70
  v_exp_f32 v71, v71
  v_exp_f32 v72, v72
  v_exp_f32 v73, v73
  v_exp_f32 v74, v74
  v_exp_f32 v75, v75
  v_exp_f32 v76, v76
  v_exp_f32 v77, v77
  v_exp_f32 v78, v78
  v_exp_f32 v79, v79
  v_cvt_pk_bf16_f32 v112, v64, v65
  v_cvt_pk_bf16_f32 v113, v66, v67
  v_cvt_pk_bf16_f32 v114, v68, v69
  v_cvt_pk_bf16_f32 v115, v70, v71
  v_cvt_pk_bf16_f32 v116, v72, v73
  v_cvt_pk_bf16_f32 v117, v74, v75
  v_cvt_pk_bf16_f32 v118, v76, v77
  v_cvt_pk_bf16_f32 v119, v78, v79
  s_waitcnt lgkmcnt(1)
  v_mfma_f32_32x32x16_bf16 v[208:223], v[160:163], v[112:115], v[208:223]
  s_waitcnt lgkmcnt(0)
  v_mfma_f32_32x32x16_bf16 v[208:223], v[164:167], v[116:119], v[208:223]
  s_nop 3
  v_subrev_u32 v26, 4112, v26
  v_subrev_u32 v25, 4112, v25
  v_subrev_u32 v27, 4112, v27
  s_add_u32 s63, s63, 1
  s_cmp_le_u32 s63, s62
  s_cbranch_scc1 L_s2_1
  s_nop 11
  v_mov_b32 v26, 0
  s_cmp_eq_u32 s59, 0
  s_cbranch_scc1 L_attdone
  v_rcp_f32 v11, v200
  s_nop 0
  v_mul_f32 v192, v192, v11
  v_mul_f32 v193, v193, v11
  v_mul_f32 v194, v194, v11
  v_mul_f32 v195, v195, v11
  v_mul_f32 v196, v196, v11
  v_mul_f32 v197, v197, v11
  v_mul_f32 v198, v198, v11
  v_mul_f32 v199, v199, v11
  v_cvt_pk_bf16_f32 v192, v192, v193
  v_cvt_pk_bf16_f32 v193, v194, v195
  v_cvt_pk_bf16_f32 v194, v196, v197
  v_cvt_pk_bf16_f32 v195, v198, v199
  buffer_store_dwordx4 v[192:195], v7, s[12:15], s41 offen sc1
  s_waitcnt vmcnt(0)
  buffer_atomic_add v34, v33, s[12:15], s53 offen offset:512 sc1
  s_branch L_attdone
L_exit:
  s_endpgm
L_codeend:
.section .rodata,"a"
.p2align 6
.amdhsa_kernel sequential_preLN__sliding_block__glu_gated_glu__prompt_kernel
  .amdhsa_next_free_vgpr 512
  .amdhsa_next_free_sgpr 102
  .amdhsa_accum_offset 256
  .amdhsa_group_segment_fixed_size 0
  .amdhsa_kernarg_size 80
  .amdhsa_user_sgpr_count 2
  .amdhsa_user_sgpr_kernarg_segment_ptr 1
  .amdhsa_system_sgpr_workgroup_id_x 1
.end_amdhsa_kernel
```
